```python
import torch

def _softmax(x, axis=-1):
    return torch.softmax(x, dim=axis)
def _gelu(x):
    return torch.nn.functional.gelu(x, approximate="tanh")
def _silu(x):
    return torch.nn.functional.silu(x)
def _sigmoid(x):
    return torch.sigmoid(x)
def _layernorm(x, axis=-1, eps=1e-5):
    m = x.mean(dim=axis, keepdim=True)
    v = x.var(dim=axis, keepdim=True, unbiased=False)
    return (x - m) / torch.sqrt(v + eps)
def _scatter_add(tgt, idx, src, axis=0):
    return tgt.clone().index_add_(axis, idx, src)
def _segment_sum(src, seg, n):
    out = torch.zeros((n,) + src.shape[1:], dtype=src.dtype)
    return out.index_add_(0, seg, src)
def _pad(x, pw):
    flat = tuple(v for pair in reversed(pw) for v in pair)
    return torch.nn.functional.pad(x, flat)

kernel_name = 'parallel_sum__sliding_block_cached__mixer_channel_mlp__decode'

def setup_inputs():

    _w = (lambda a: (lambda t: t.to(torch.bfloat16) if t.is_floating_point() else t)(torch.as_tensor(a)))
    def _A_setup():
        B, Sq, D = 1, 1, 576
        Hq, Hkv, Sk, Dh = 32, 16, 16384, 128
        assert Hq % Hkv == 0, (Hq, Hkv)
        return {
            "x": _w((lambda *s: torch.randn(*s, dtype=torch.bfloat16) * 0.05)(B, Sq, D)),
            "k_cache": _w((lambda *s: torch.randn(*s, dtype=torch.bfloat16) * 3.2)(B, Hkv, Sk, Dh)),
            "v_cache": _w((lambda *s: torch.randn(*s, dtype=torch.bfloat16) * 0.4)(B, Hkv, Sk, Dh)),
            "wq": _w((lambda *s: torch.randn(*s, dtype=torch.bfloat16) * 3.2)(D, Hq * Dh) * (D ** -0.5)),
            "wo": _w((lambda *s: torch.randn(*s, dtype=torch.bfloat16) * 0.4)(Hq * Dh, D) * ((Hq * Dh) ** -0.5)),
        }
    _A_in = _A_setup()

    def _B_setup():
        B, S, D, F = 1, 1, 576, 4608
        return {
            "x": _w((lambda *s: torch.randn(*s, dtype=torch.bfloat16) * 0.05)(B, S, D)),
            "w1": _w((lambda *s: torch.randn(*s, dtype=torch.bfloat16) * 3.2)(D, F) * (D ** -0.5)),
            "b1": _w((lambda *s: torch.randn(*s, dtype=torch.bfloat16) * 1.6)(F)),
            "w2": _w((lambda *s: torch.randn(*s, dtype=torch.bfloat16) * 0.1)(F, D) * (F ** -0.5)),
            "b2": _w((lambda *s: torch.randn(*s, dtype=torch.bfloat16) * 0.1)(D)),
        }
    _B_in = _B_setup()

    return {
        "A_x": _A_in["x"],
        "A_k_cache": _A_in["k_cache"],
        "A_v_cache": _A_in["v_cache"],
        "A_wq": _A_in["wq"],
        "A_wo": _A_in["wo"],
        "B_x": _B_in["x"],
        "B_w1": _B_in["w1"],
        "B_b1": _B_in["b1"],
        "B_w2": _B_in["w2"],
        "B_b2": _B_in["b2"],
    }

def reference(A_x, A_k_cache, A_v_cache, A_wq, A_wo, B_x, B_w1, B_b1, B_w2, B_b2):
    def _A_ref(x, k_cache, v_cache, wq, wo):
        B, Sq, D = x.shape
        Hq, Dh = 32, 128
        Hkv, Sk = k_cache.shape[1], k_cache.shape[2]
        W = min(4096, max(256, Sk // 4))
        rep = Hq // Hkv
        q = (lambda x, *d: x.permute(*d))((x @ wq).reshape(B, Sq, Hq, Dh), 0, 2, 1, 3)
        k = (lambda x, n, axis: torch.repeat_interleave(x, n, dim=axis))(k_cache[:, :, Sk - W:, :], rep, axis=1)
        v = (lambda x, n, axis: torch.repeat_interleave(x, n, dim=axis))(v_cache[:, :, Sk - W:, :], rep, axis=1)
        scores = torch.einsum("bhqd,bhkd->bhqk", q, k) * (Dh ** -0.5)
        p = _softmax(scores, axis=-1)
        o = torch.einsum("bhqk,bhkd->bhqd", p, v)
        return (lambda x, *d: x.permute(*d))(o, 0, 2, 1, 3).reshape(B, Sq, Hq * Dh) @ wo

    def _B_ref(x, w1, b1, w2, b2):
        y = _layernorm(x, axis=-1)
        h = _gelu(torch.einsum("bsd,df->bsf", y, w1) + b1)
        return torch.einsum("bsf,fd->bsd", h, w2) + b2

    x = A_x
    xn = _layernorm(x, axis=-1)
    return x + _A_ref(xn, A_k_cache, A_v_cache, A_wq, A_wo) + _B_ref(xn, B_w1, B_b1, B_w2, B_b2)
```

```asm
; @launch grid=(256,1,1) block=(320,1,1) lds=12800
.amdgcn_target "amdgcn-amd-amdhsa--gfx950"
.text
.globl parallel_sum__sliding_block_cached__mixer_channel_mlp__decode_kernel
.p2align 12
.p2align 8
.type parallel_sum__sliding_block_cached__mixer_channel_mlp__decode_kernel,@function
parallel_sum__sliding_block_cached__mixer_channel_mlp__decode_kernel:
    s_cmp_ge_u32 s2, 256
    s_cbranch_scc1 L_end
    s_memrealtime s[66:67]
    s_load_dwordx16 s[4:19], s[0:1], 0
    s_load_dwordx8 s[20:27], s[0:1], 64
    s_load_dwordx2 s[28:29], s[0:1], 96
    v_lshrrev_b32 v2, 6, v0
    v_and_b32 v1, 63, v0
    v_mov_b32 v4, 0
    v_mov_b32 v5, 0
    v_readfirstlane_b32 s34, v2
    v_mov_b32 v6, 0
    v_mov_b32 v7, 0
    s_sub_u32 s34, s34, 1
    s_cselect_b32 s34, 4, s34
    v_lshlrev_b32 v9, 4, v0
    ds_write_b128 v9, v[4:7]
    v_lshrrev_b32 v20, 3, v1
    v_and_b32 v22, 7, v1
    v_lshlrev_b32 v22, 4, v22
    s_and_b32 s30, s2, 7
    s_lshr_b32 s31, s2, 3
    s_lshl_b32 s32, s30, 1
    s_lshr_b32 s38, s31, 4
    s_add_u32 s32, s32, s38
    s_and_b32 s33, s31, 15
    s_lshr_b32 s38, s33, 2
    s_mul_i32 s48, s38, 144
    s_lshl_b32 s38, s34, 5
    s_add_u32 s48, s48, s38
    s_lshl_b32 s40, s48, 13
    s_lshl_b32 s38, s32, 9
    s_add_u32 s40, s40, s38
    s_and_b32 s38, s33, 3
    s_lshl_b32 s38, s38, 7
    s_add_u32 s40, s40, s38
    s_cmp_eq_u32 s34, 4
    s_cselect_b32 s38, 14, 15
    v_lshlrev_b32 v32, s38, v20
    v_add3_u32 v32, v32, v22, s40
    v_add_u32 v33, 0x2000, v32
    s_mul_i32 s51, s31, 5
    s_add_u32 s50, s51, s34
    s_mul_i32 s49, s50, 57
    s_lshr_b32 s49, s49, 10
    s_mul_i32 s38, s49, 18
    s_sub_u32 s50, s50, s38
    s_mul_i32 s41, s50, 294912
    s_mul_i32 s42, s30, 1152
    s_add_u32 s41, s41, s42
    s_lshl_b32 s38, s49, 7
    s_add_u32 s41, s41, s38
    v_mul_u32_u24 v34, 36864, v20
    v_add3_u32 v34, v34, v22, s41
    v_add_u32 v35, 9216, v34
    v_add_u32 v36, 9216, v35
    v_add_u32 v37, 9216, v36
    v_add_u32 v38, 0x2000, v33
    v_add_u32 v39, 0x2000, v38
    v_lshlrev_b32 v16, 4, v1
    v_lshlrev_b32 v10, 1, v1
    v_mov_b32 v156, 0
    s_lshl_b32 s43, s32, 6
    s_add_u32 s43, s43, s33
    s_add_u32 s43, s43, 48
    s_lshl_b32 s43, s43, 3
    s_and_b32 s38, s31, 7
    s_add_u32 s43, s43, s38
    s_lshl_b32 s43, s43, 2
    s_and_b32 s38, s34, 3
    s_add_u32 s43, s43, s38
    s_lshl_b32 s43, s43, 11
    v_lshl_add_u32 v23, v22, 4, s43
    v_and_b32 v11, 0x30, v1
    v_and_b32 v12, 8, v1
    v_lshl_add_u32 v11, v12, 3, v11
    v_add_u32 v23, v23, v11
    v_xor_b32 v9, 0x2000, v23
    s_cmp_eq_u32 s34, 4
    s_waitcnt lgkmcnt(0)
    s_load_dword s35, s[28:29], 0
    s_cbranch_scc0 L_g
    s_setprio 3
    global_load_dwordx4 v[152:155], v16, s[4:5]
    global_load_short_d16_hi v156, v10, s[4:5] offset:1024
    s_branch L_a
L_g:
    s_lshl3_add_u32 s38, s2, s34
    s_cmp_eq_u32 s38, 8
    s_cbranch_scc0 L_a
    v_mov_b32 v11, s66
    s_mov_b64 exec, 1
    global_store_dword v4, v11, s[28:29] offset:1024 sc0 sc1
    s_mov_b64 exec, -1
    s_cmp_eq_u32 s34, 4
L_a:
    global_load_dwordx4 v[56:59], v32, s[10:11] offset:0 nt
    global_load_dwordx4 v[60:63], v33, s[10:11] offset:0 nt
    global_load_dwordx4 v[72:75], v34, s[16:17] offset:0 nt
    global_load_dwordx4 v[76:79], v35, s[16:17] offset:0 nt
    global_load_dwordx4 v[80:83], v36, s[16:17] offset:0 nt
    global_load_dwordx4 v[84:87], v37, s[16:17] offset:0 nt
    s_barrier
    s_cbranch_scc1 L_b
    global_load_dwordx4 v[64:67], v38, s[10:11] offset:0 nt
    global_load_dwordx4 v[68:71], v39, s[10:11] offset:0 nt
    global_load_dwordx4 v[88:91], v23, s[6:7] offset:0 nt
    global_load_dwordx4 v[92:95], v23, s[6:7] offset:128 nt
    s_mov_b64 exec, 0
    s_cmp_eq_u32 s34, 0
    s_cbranch_scc1 L_hop0
    s_cmp_eq_u32 s34, 1
    s_cbranch_scc1 L_hop1
    s_cmp_eq_u32 s34, 2
    s_cbranch_scc1 L_hop2
    s_branch L_hop3
L_hret:
    s_mov_b64 exec, -1
L_b:
    v_mov_b32 v3, 0
    v_mov_b32 v8, 1
    s_mov_b32 s37, 100000
    s_add_u32 s38, s51, 4
    s_mul_i32 s38, s38, 57
    s_lshr_b32 s38, s38, 10
    s_mul_i32 s51, s51, 57
    s_lshr_b32 s51, s51, 10
    s_cmp_lg_u32 s38, s51
    s_cselect_b32 s57, -1, 0xffff
    s_sub_u32 s49, s49, s51
    s_lshl_b32 s49, s49, 9
    s_mul_i32 s38, s33, 9
    s_lshr_b32 s54, s38, 4
    s_add_u32 s38, s38, 8
    s_lshr_b32 s38, s38, 4
    s_cmp_lg_u32 s38, s54
    s_cselect_b32 s58, -1, 0xffff
    s_lshr_b32 s38, s31, 4
    s_lshl_b32 s39, s33, 1
    s_add_u32 s38, s38, s39
    s_mul_i32 s53, s38, 5
    s_add_u32 s53, s53, s34
    s_mul_i32 s52, s53, 57
    s_lshr_b32 s52, s52, 10
    s_mul_i32 s38, s52, 18
    s_sub_u32 s53, s53, s38
    s_mul_i32 s44, s42, 576
    s_lshl_b32 s39, s52, 7
    s_add_u32 s44, s44, s39
    s_sub_u32 s52, s52, s54
    s_lshl_b32 s52, s52, 9
    s_cmp_eq_u32 s34, 4
    s_cselect_b32 s39, -18, 2
    s_and_b32 s38, s33, 1
    s_mul_i32 s39, s39, s38
    s_mul_i32 s38, s33, 18
    s_add_u32 s38, s38, s39
    s_lshl2_add_u32 s38, s34, s38
    s_lshr_b32 s55, s38, 5
    s_bfe_u32 s56, s38, 0x30002
    s_lshl3_add_u32 s38, s32, s56
    s_mul_i32 s45, s38, 36864
    s_lshl_b32 s39, s55, 7
    s_add_u32 s45, s45, s39
    s_sub_u32 s55, s55, s54
    s_lshl_b32 s55, s55, 9
    s_mov_b32 s26, 0x00ff00ff
    s_mov_b32 s27, 0xff00ff00
    s_mov_b32 s59, 0x07060501
    s_mov_b32 s60, 0x07060502
    s_mov_b32 s61, 0x07060503
    s_mov_b32 s62, 0x0c04000c
    v_and_b32 v10, 1, v1
    v_lshlrev_b32 v10, 4, v10
    v_mov_b32 v11, 0xffff
    v_lshlrev_b32 v10, v10, v11
    v_bfe_u32 v11, v1, 1, 2
    v_cmp_eq_u32 vcc, 0, v11
    s_nop 1
    v_cndmask_b32 v4, 0, v10, vcc
    v_cmp_eq_u32 vcc, 1, v11
    s_nop 1
    v_cndmask_b32 v5, 0, v10, vcc
    v_cmp_eq_u32 vcc, 2, v11
    s_nop 1
    v_cndmask_b32 v6, 0, v10, vcc
    v_cmp_eq_u32 vcc, 3, v11
    s_nop 1
    v_cndmask_b32 v7, 0, v10, vcc
    v_lshrrev_b32 v14, 1, v22
    v_and_b32 v10, 2, v20
    v_lshl_add_u32 v14, v10, 7, v14
    v_add_u32 v15, s55, v14
    v_lshlrev_b32 v21, 5, v1
    s_lshl_b32 s38, s32, 7
    s_add_u32 s38, s38, s56
    s_lshl_b32 s38, s38, 7
    s_add_u32 s38, s38, 524288
    v_lshl_add_u32 v17, v20, 11, s38
    v_lshl_add_u32 v17, v22, 0, v17
    s_lshl_b32 s38, s32, 7
    s_lshr_b32 s39, s56, 2
    s_add_u32 s38, s38, s39
    s_lshl_b32 s38, s38, 4
    s_add_u32 s38, s38, 458752
L_nohop0:
    s_nop 0
    v_lshl_add_u32 v18, v20, 8, s38
    s_mul_i32 s38, s32, 24
    s_add_u32 s38, s38, s33
    s_add_u32 s38, s38, s54
    s_lshl_b32 s38, s38, 8
    s_add_u32 s38, s38, 1048576
    v_add_u32 v19, s38, v16
    s_lshl4_add_u32 s47, s32, s33
    s_waitcnt lgkmcnt(0)
    s_mul_i32 s36, s35, 0x9E3779B1
    s_add_u32 s36, s36, 0x7F4A7C15
    s_bitset1_b32 s36, 31
    s_cmp_eq_u32 s34, 4
    s_cbranch_scc0 L_str
L_w4:
    s_lshr_b32 s63, s31, 4
    s_sub_u32 s63, 2, s63
    s_cmp_ge_u32 s33, 14
    s_cselect_b32 s63, s63, 0
    s_add_u32 s0, s33, 2
    s_lshl_b32 s38, s47, 8
    s_add_u32 s38, s38, 65536
    v_add_u32 v229, s38, v16
    s_mul_i32 s38, s30, 40
    s_add_u32 s38, s38, s31
    s_add_u32 s38, s38, s51
    s_lshl_b32 s38, s38, 8
    s_add_u32 s38, s38, 262144
    v_add_u32 v230, s38, v16
    s_lshl_b32 s38, s47, 7
    s_add_u32 s38, s38, 458752
    v_add_u32 v231, s38, v16
    s_min_u32 s39, s2, 35
    s_lshl_b32 s38, s39, 5
    v_and_b32 v10, 3, v1
    v_lshl_add_u32 v228, v10, 3, s38
    v_lshrrev_b32 v11, 4, v1
    v_lshl_add_u32 v228, v11, 1, v228
    s_lshr_b32 s38, s39, 2
    s_mul_i32 s14, s38, 1425
    s_lshr_b32 s14, s14, 9
    s_and_b32 s39, s39, 3
    s_lshl2_add_u32 s39, s14, s39
    s_lshl_b32 s39, s39, 6
    s_add_u32 s39, s39, 1048576
    v_lshrrev_b32 v11, 2, v1
    v_mul_u32_u24 v11, 6144, v11
    v_lshl_add_u32 v10, v10, 4, s39
    v_add_u32 v234, v10, v11
    s_and_b32 s38, s38, 3
    s_cselect_b32 s14, 2, 1
    s_cselect_b32 s15, 1.0, 0
    s_lshl_b32 s14, s14, 8
    v_add_u32 v235, s14, v234
    s_lshl_b32 s40, s47, 10
    s_add_u32 s40, s40, 524288
    s_getreg_b32 s47, hwreg(HW_REG_XCC_ID, 0, 4)
    s_xor_b32 s47, s47, s36
    v_add_u32 v222, 5120, v21
    v_lshrrev_b32 v223, 3, v222
    v_add_u32 v223, 6528, v223
    v_mov_b32 v224, 0
    v_mov_b32 v225, v230
    s_mov_b32 s46, 0
    s_waitcnt vmcnt(6)
    s_cmp_lg_u32 s63, 1
    s_cbranch_scc1 L_w4a
    s_sub_u32 s38, s0, s50
    s_mul_i32 s38, s38, 294912
    v_add_u32 v9, s38, v34
    global_load_dwordx4 v[120:123], v9, s[16:17] nt
    v_add_u32 v9, s38, v35
    global_load_dwordx4 v[124:127], v9, s[16:17] nt
    v_add_u32 v9, s38, v36
    global_load_dwordx4 v[128:131], v9, s[16:17] nt
    v_add_u32 v9, s38, v37
    global_load_dwordx4 v[132:135], v9, s[16:17] nt
L_w4a:
    v_lshlrev_b32 v164, 16, v152
    v_and_b32 v165, 0xffff0000, v152
    v_lshlrev_b32 v166, 16, v153
    v_and_b32 v167, 0xffff0000, v153
    v_lshlrev_b32 v168, 16, v154
    v_and_b32 v169, 0xffff0000, v154
    v_lshlrev_b32 v170, 16, v155
    v_and_b32 v171, 0xffff0000, v155
    v_mov_b32 v172, v156
L_ln:
    v_add_f32 v162, v164, v165
    v_mul_f32 v163, v164, v164
    v_fmac_f32 v163, v165, v165
    v_add_f32 v162, v162, v166
    v_fmac_f32 v163, v166, v166
    v_add_f32 v162, v162, v167
    v_fmac_f32 v163, v167, v167
    v_add_f32 v162, v162, v168
    v_fmac_f32 v163, v168, v168
    v_add_f32 v162, v162, v169
    v_fmac_f32 v163, v169, v169
    v_add_f32 v162, v162, v170
    v_fmac_f32 v163, v170, v170
    v_add_f32 v162, v162, v171
    v_fmac_f32 v163, v171, v171
    v_add_f32 v162, v162, v172
    v_fmac_f32 v163, v172, v172
    s_nop 1
    v_permlane32_swap_b32 v162, v163
    v_add_f32 v162, v162, v163
    s_nop 1
    v_add_f32_dpp v162, v162, v162 row_ror:8 row_mask:0xf bank_mask:0xf
    s_nop 1
    v_add_f32_dpp v162, v162, v162 row_ror:4 row_mask:0xf bank_mask:0xf
    s_nop 1
    v_add_f32_dpp v162, v162, v162 row_ror:2 row_mask:0xf bank_mask:0xf
    s_nop 1
    v_add_f32_dpp v162, v162, v162 row_ror:1 row_mask:0xf bank_mask:0xf
    v_mov_b32 v163, v162
    s_nop 1
    v_permlane16_swap_b32 v162, v163
    v_add_f32 v162, v162, v163
    v_mul_f32 v162, 0x3ae38e39, v162
    v_mov_b32 v163, v162
    s_mov_b32 s38, 0xffff0000
    s_nop 0
    v_permlane32_swap_b32 v162, v163
    v_fma_f32 v163, -v162, v162, v163
    v_cvt_pk_bf16_f32 v162, v162, v163
    v_and_b32 v163, s38, v162
    v_lshlrev_b32 v162, 16, v162
    v_add_f32 v163, 0x3727c5ac, v163
    v_cvt_pk_bf16_f32 v163, v163, v163
    v_and_b32 v163, s38, v163
    v_sqrt_f32 v163, v163
    v_sub_f32 v164, v164, v162
    v_sub_f32 v165, v165, v162
    v_sub_f32 v166, v166, v162
    v_sub_f32 v167, v167, v162
    v_sub_f32 v168, v168, v162
    v_sub_f32 v169, v169, v162
    v_sub_f32 v170, v170, v162
    v_sub_f32 v171, v171, v162
    v_sub_f32 v172, v172, v162
    v_cvt_pk_bf16_f32 v163, v163, v163
    v_and_b32 v163, s38, v163
    v_rcp_f32 v163, v163
    v_cvt_pk_bf16_f32 v164, v164, v165
    v_and_b32 v165, s38, v164
    v_lshlrev_b32 v164, 16, v164
    v_cvt_pk_bf16_f32 v166, v166, v167
    v_and_b32 v167, s38, v166
    v_lshlrev_b32 v166, 16, v166
    v_cvt_pk_bf16_f32 v168, v168, v169
    v_and_b32 v169, s38, v168
    v_lshlrev_b32 v168, 16, v168
    v_cvt_pk_bf16_f32 v170, v170, v171
    v_and_b32 v171, s38, v170
    v_lshlrev_b32 v170, 16, v170
    v_cvt_pk_bf16_f32 v172, v172, v172
    v_lshlrev_b32 v172, 16, v172
    v_mul_f32 v164, v164, v163
    v_cvt_pk_bf16_f32 v176, v164, v164
    v_mul_f32 v165, v165, v163
    v_cvt_pk_bf16_f32 v177, v165, v165
    v_mul_f32 v166, v166, v163
    v_cvt_pk_bf16_f32 v178, v166, v166
    v_mul_f32 v167, v167, v163
    v_cvt_pk_bf16_f32 v179, v167, v167
    v_mul_f32 v168, v168, v163
    v_cvt_pk_bf16_f32 v180, v168, v168
    v_mul_f32 v169, v169, v163
    v_cvt_pk_bf16_f32 v181, v169, v169
    v_mul_f32 v170, v170, v163
    v_cvt_pk_bf16_f32 v182, v170, v170
    v_mul_f32 v171, v171, v163
    v_cvt_pk_bf16_f32 v183, v171, v171
    v_mul_f32 v172, v172, v163
    v_cvt_pk_bf16_f32 v184, v172, v172
    ds_write_b128 v222, v[176:179]
    ds_write_b128 v222, v[180:183] offset:16
    ds_write_b32 v223, v184
    ds_write_b32 v224, v8
    s_cmp_lg_u32 s46, 0
    s_cbranch_scc1 L_lnd
    s_mov_b32 s46, 1
    v_and_b32 v164, s38, v176
    v_and_b32 v165, s38, v177
    v_and_b32 v166, s38, v178
    v_and_b32 v167, s38, v179
    v_and_b32 v168, s38, v180
    v_and_b32 v169, s38, v181
    v_and_b32 v170, s38, v182
    v_and_b32 v171, s38, v183
    v_and_b32 v172, s38, v184
    v_add_u32 v222, 2560, v222
    v_add_u32 v223, 2560, v223
    v_mov_b32 v224, 4
    s_branch L_ln
L_lnd:
    s_lshl_b32 s38, s48, 2
    v_lshl_add_u32 v11, v20, 3, s38
    ds_read_b64 v[188:189], v11 offset:5120
L_nohop1:
    s_nop 0
    s_lshl_b32 s38, s50, 7
    v_lshl_add_u32 v11, v20, 4, s38
    ds_read_b128 v[192:195], v11 offset:7680
    s_lshl_b32 s38, s0, 7
    v_lshl_add_u32 v11, v20, 4, s38
    ds_read_b128 v[196:199], v11 offset:7680
    s_waitcnt vmcnt(0) lgkmcnt(0)
    v_and_b32 v32, v188, v4
    v_and_b32 v33, v188, v5
    v_and_b32 v34, v188, v6
    v_and_b32 v35, v188, v7
    s_nop 1
    v_mfma_f32_16x16x32_bf16 v[48:51], v[56:59], v[32:35], 0
    v_and_b32 v36, v189, v4
    v_and_b32 v37, v189, v5
    v_and_b32 v38, v189, v6
    v_and_b32 v39, v189, v7
    s_nop 1
    v_mfma_f32_16x16x32_bf16 v[48:51], v[60:63], v[36:39], v[48:51]
    s_mov_b64 exec, s[26:27]
    s_nop 6
    v_cvt_f64_f32 v[32:33], v48
    ds_add_f64 v14, v[32:33] offset:512
    v_cvt_f64_f32 v[34:35], v49
    ds_add_f64 v14, v[34:35] offset:576
    v_cvt_f64_f32 v[36:37], v50
    ds_add_f64 v14, v[36:37] offset:640
    v_cvt_f64_f32 v[38:39], v51
    ds_add_f64 v14, v[38:39] offset:704
    s_mov_b64 exec, -1
    v_and_b32 v32, v192, v4
    v_and_b32 v33, v192, v5
    v_and_b32 v34, v192, v6
    v_and_b32 v35, v192, v7
    s_nop 1
    v_mfma_f32_16x16x32_bf16 v[48:51], v[72:75], v[32:35], 0
    v_and_b32 v36, v193, v4
    v_and_b32 v37, v193, v5
    v_and_b32 v38, v193, v6
    v_and_b32 v39, v193, v7
    s_nop 1
    v_mfma_f32_16x16x32_bf16 v[48:51], v[76:79], v[36:39], v[48:51]
    v_and_b32 v40, v194, v4
    v_and_b32 v41, v194, v5
    v_and_b32 v42, v194, v6
    v_and_b32 v43, v194, v7
    s_nop 1
    v_mfma_f32_16x16x32_bf16 v[48:51], v[80:83], v[40:43], v[48:51]
    v_and_b32 v44, v195, v4
    v_and_b32 v45, v195, v5
    v_and_b32 v46, v195, v6
    v_and_b32 v47, v195, v7
    s_nop 1
    v_mfma_f32_16x16x32_bf16 v[48:51], v[84:87], v[44:47], v[48:51]
    s_cmp_lg_u32 s63, 1
    s_cbranch_scc1 L_w4d
    v_and_b32 v32, v196, v4
    v_and_b32 v33, v196, v5
    v_and_b32 v34, v196, v6
    v_and_b32 v35, v196, v7
    s_nop 1
    v_mfma_f32_16x16x32_bf16 v[48:51], v[120:123], v[32:35], v[48:51]
    v_and_b32 v36, v197, v4
    v_and_b32 v37, v197, v5
    v_and_b32 v38, v197, v6
    v_and_b32 v39, v197, v7
    s_nop 1
    v_mfma_f32_16x16x32_bf16 v[48:51], v[124:127], v[36:39], v[48:51]
    v_and_b32 v40, v198, v4
    v_and_b32 v41, v198, v5
    v_and_b32 v42, v198, v6
    v_and_b32 v43, v198, v7
    s_nop 1
    v_mfma_f32_16x16x32_bf16 v[48:51], v[128:131], v[40:43], v[48:51]
    v_and_b32 v44, v199, v4
    v_and_b32 v45, v199, v5
    v_and_b32 v46, v199, v6
    v_and_b32 v47, v199, v7
    s_nop 1
    v_mfma_f32_16x16x32_bf16 v[48:51], v[132:135], v[44:47], v[48:51]
L_w4d:
    v_add_u32 v11, s49, v14
    s_mov_b64 exec, s[26:27]
    s_nop 5
    v_cvt_f64_f32 v[32:33], v48
    ds_add_f64 v11, v[32:33] offset:1024
    v_cvt_f64_f32 v[34:35], v49
    ds_add_f64 v11, v[34:35] offset:1088
    v_cvt_f64_f32 v[36:37], v50
    ds_add_f64 v11, v[36:37] offset:1152
    v_cvt_f64_f32 v[38:39], v51
    ds_add_f64 v11, v[38:39] offset:1216
    s_mov_b64 exec, -1
    v_add_u32 v223, s40, v16
    v_mov_b32 v178, 0
    v_mov_b32 v179, 0
    s_lshl_b32 s38, s32, 12
    s_add_u32 s38, s38, 65536
    v_add_u32 v9, s38, v16
    s_xor_b32 s38, s38, 0x1000
    v_and_b32 v232, 15, v1
    v_lshl_add_u32 v232, v232, 8, s38
    s_mov_b32 s1, 4
P_21:
    ds_read_b32 v10, v3 offset:16
    ds_read_b128 v[200:203], v21 offset:512
    ds_read_b128 v[204:207], v21 offset:528
    s_waitcnt lgkmcnt(0)
    v_readfirstlane_b32 s3, v10
    s_cmp_ge_u32 s3, 4
    s_cbranch_scc1 D_22
    s_sub_u32 s37, s37, 1
    s_cbranch_scc0 P_21
    s_mov_b32 s37, 0
D_22:
    v_cvt_f32_f64 v200, v[200:201]
    v_cvt_f32_f64 v201, v[202:203]
    v_cvt_f32_f64 v202, v[204:205]
    v_cvt_f32_f64 v203, v[206:207]
    v_perm_b32 v200, v200, v203, s59
    v_perm_b32 v201, v201, v203, s60
    v_perm_b32 v202, v202, v203, s61
    v_mov_b32 v203, s47
    s_mov_b32 exec_lo, 0xffff
    s_mov_b32 exec_hi, 0
    global_store_dwordx4 v229, v[200:203], s[28:29]
    s_mov_b64 exec, -1
P_23:
    ds_read_b32 v10, v3 offset:20
    ds_read_b128 v[208:211], v21 offset:1024
    ds_read_b128 v[212:215], v21 offset:1040
    s_waitcnt lgkmcnt(0)
    v_readfirstlane_b32 s3, v10
    s_cmp_ge_u32 s3, 4
    s_cbranch_scc1 D_24
    s_sub_u32 s37, s37, 1
    s_cbranch_scc0 P_23
    s_mov_b32 s37, 0
D_24:
    v_cvt_f32_f64 v208, v[208:209]
    v_cvt_f32_f64 v209, v[210:211]
    v_cvt_f32_f64 v210, v[212:213]
    v_cvt_f32_f64 v211, v[214:215]
    v_perm_b32 v208, v208, v211, s59
    v_perm_b32 v209, v209, v211, s60
    v_perm_b32 v210, v210, v211, s61
    v_mov_b32 v211, s36
    s_mov_b32 exec_lo, s57
    s_mov_b32 exec_hi, 0
    global_store_dwordx4 v230, v[208:211], s[28:29]
    s_mov_b64 exec, -1
    global_load_ushort v226, v228, s[4:5]
    global_load_ushort v227, v228, s[22:23]
    global_store_dwordx4 v223, v[176:179], s[28:29]
    s_mov_b64 exec, 0xff
    global_store_dwordx4 v231, v[176:179], s[28:29]
    s_mov_b64 exec, -1
    global_load_dword v236, v3, s[24:25]
    global_load_dword v236, v3, s[18:19]
L_qg:
    global_load_dwordx4 v[88:91], v9, s[28:29] offset:0 sc1
    global_load_dwordx4 v[92:95], v9, s[28:29] offset:1024 sc1
    global_load_dwordx4 v[96:99], v9, s[28:29] offset:2048 sc1
    global_load_dwordx4 v[100:103], v9, s[28:29] offset:3072 sc1
    global_load_dword v233, v232, s[28:29] offset:12 sc1
    s_waitcnt vmcnt(0)
    v_xor_b32 v10, s47, v91
    v_xor_b32 v11, s47, v95
    v_xor_b32 v12, s47, v99
    v_or3_b32 v10, v10, v11, v12
    v_xor_b32 v11, s47, v103
    v_xor_b32 v12, s47, v233
    v_or3_b32 v10, v10, v11, v12
    v_cmp_lt_u32 vcc, 15, v10
    s_cbranch_vccz L_qd
    s_sub_u32 s1, s1, 1
    s_cbranch_scc0 L_qr
    s_mov_b32 exec_lo, 0xffff
    s_mov_b32 exec_hi, 0
    global_store_dwordx4 v229, v[200:203], s[28:29] sc1
    s_mov_b64 exec, -1
L_qr:
    s_sub_u32 s37, s37, 1
    s_cbranch_scc0 L_qg
    s_mov_b32 s37, 0
L_qd:
    v_cmp_ne_u32 vcc, 0, v10
    s_cbranch_vccz L_qf
    s_mov_b32 s46, 2
    s_mov_b32 exec_lo, 0xffff
    s_mov_b32 exec_hi, 0
    global_store_dwordx4 v229, v[200:203], s[28:29] sc1
    s_mov_b64 exec, -1
    s_mov_b32 exec_lo, s57
    s_mov_b32 exec_hi, 0
    global_store_dwordx4 v230, v[208:211], s[28:29] sc1
    s_mov_b64 exec, -1
L_qf:
    v_perm_b32 v91, v89, v88, s62
    v_lshl_or_b32 v91, v90, 24, v91
    v_perm_b32 v95, v93, v92, s62
    v_lshl_or_b32 v95, v94, 24, v95
L_nohop2:
    s_nop 0
    v_perm_b32 v99, v97, v96, s62
    v_lshl_or_b32 v99, v98, 24, v99
    v_perm_b32 v103, v101, v100, s62
    v_lshl_or_b32 v103, v102, 24, v103
    v_add_f32 v88, v88, v92
    v_add_f32 v96, v96, v100
    v_add_f32 v88, v88, v96
    v_add_f32 v89, v89, v93
    v_add_f32 v97, v97, v101
    v_add_f32 v89, v89, v97
    v_add_f32 v90, v90, v94
    v_add_f32 v98, v98, v102
    v_add_f32 v90, v90, v98
    v_add_f32 v91, v91, v95
    v_add_f32 v99, v99, v103
    v_add_f32 v91, v91, v99
    v_lshrrev_b32 v11, 1, v16
    v_mov_b32 v10, s46
    v_cvt_pk_bf16_f32 v88, v88, v89
    v_cvt_pk_bf16_f32 v89, v90, v91
    ds_write_b64 v11, v[88:89] offset:10240
    ds_write_b32 v3, v10 offset:8
    v_lshlrev_b32 v226, 16, v226
    v_lshlrev_b32 v227, 16, v227
    v_add_f32 v226, v226, v227
L_w4p:
    v_mov_b32 v90, s36
P_25:
    ds_read_b128 v[152:155], v21 offset:64
    ds_read_b128 v[156:159], v21 offset:80
    s_waitcnt lgkmcnt(0)
    v_min_u32 v10, v153, v155
    v_min3_u32 v10, v10, v157, v159
    v_cmp_ne_u32 vcc, 0, v10
    s_and_b32 vcc_lo, vcc_lo, 3
    s_cmp_eq_u32 vcc_lo, 3
    s_cbranch_scc1 D_26
    s_sub_u32 s37, s37, 1
    s_cbranch_scc0 P_25
    s_mov_b32 s37, 0
D_26:
    v_max_f32 v88, v152, v154
    v_max3_f32 v88, v88, v156, v158
    v_sub_f32 v152, v152, v88
    v_exp_f32 v152, v152
    v_sub_f32 v154, v154, v88
    v_exp_f32 v154, v154
    v_sub_f32 v156, v156, v88
    v_exp_f32 v156, v156
    v_sub_f32 v158, v158, v88
    v_exp_f32 v158, v158
    v_mul_f32 v89, v152, v153
    v_fmac_f32 v89, v154, v155
    v_fmac_f32 v89, v156, v157
    v_fmac_f32 v89, v158, v159
    s_mov_b64 exec, 3
    s_cmp_lt_u32 s46, 2
    s_cbranch_scc1 L_w4s
    global_store_dwordx3 v231, v[88:90], s[28:29] sc1
    s_branch L_w4t
L_w4s:
    global_store_dwordx3 v231, v[88:90], s[28:29]
L_w4t:
    s_mov_b64 exec, -1
    s_lshr_b32 s38, s53, 1
    s_lshr_b32 s39, 0x4a, s38
    s_and_b32 s39, s39, 1
    s_mul_i32 s68, s39, 0x10101010
    s_or_b32 s68, s68, 0x0f0f0f0f
    s_add_u32 s39, s39, 3
    s_lshl_b32 s39, s39, 4
    s_mul_i32 s38, s38, 4715
    s_lshr_b32 s38, s38, 10
    s_mul_i32 s14, s30, 40
    s_add_u32 s38, s38, s14
    s_and_b32 s14, s53, 1
    s_lshl1_add_u32 s38, s38, s14
    s_lshl_b32 s38, s38, 7
    s_add_u32 s38, s38, 262144
    v_min_u32 v160, s39, v22
    v_lshl_add_u32 v160, v160, 4, s38
    v_lshl_add_u32 v160, v20, 4, v160
    s_lshl_b32 s38, s53, 6
    s_add_u32 s38, s38, s42
    v_lshl_add_u32 v26, v20, 3, s38
    global_load_dwordx4 v[52:55], v160, s[28:29] sc1
    global_load_dwordx2 v[26:27], v26, s[18:19]
    s_mul_i32 s38, s53, 36864
    s_add_u32 s38, s38, s44
    v_mul_u32_u24 v9, 4608, v20
    v_add3_u32 v9, v9, v22, s38
    global_load_dwordx4 v[56:59], v9, s[20:21] offset:0 nt
    global_load_dwordx4 v[60:63], v9, s[20:21] offset:1152 nt
    global_load_dwordx4 v[64:67], v9, s[20:21] offset:2304 nt
    global_load_dwordx4 v[68:71], v9, s[20:21] offset:3456 nt
    s_cmp_lg_u32 s63, 2
    s_cbranch_scc1 L_w4e
    s_lshr_b32 s38, s0, 1
    s_lshr_b32 s39, 0x4a, s38
    s_and_b32 s39, s39, 1
    s_mul_i32 s40, s39, 0x10101010
    s_or_b32 s40, s40, 0x0f0f0f0f
    s_add_u32 s39, s39, 3
    s_lshl_b32 s39, s39, 4
    s_mul_i32 s38, s38, 4715
    s_lshr_b32 s38, s38, 10
    s_mul_i32 s14, s30, 40
    s_add_u32 s38, s38, s14
    s_and_b32 s14, s0, 1
    s_lshl1_add_u32 s38, s38, s14
    s_lshl_b32 s38, s38, 7
    s_add_u32 s38, s38, 262144
    v_min_u32 v225, s39, v22
    v_lshl_add_u32 v225, v225, 4, s38
    v_lshl_add_u32 v225, v20, 4, v225
    s_lshl_b32 s38, s0, 6
    s_add_u32 s38, s38, s42
    v_lshl_add_u32 v220, v20, 3, s38
    global_load_dwordx4 v[216:219], v225, s[28:29] sc1
    global_load_dwordx2 v[220:221], v220, s[18:19]
    s_mul_i32 s38, s0, 36864
    s_add_u32 s38, s38, s44
    v_mul_u32_u24 v9, 4608, v20
    v_add3_u32 v9, v9, v22, s38
    global_load_dwordx4 v[120:123], v9, s[20:21] offset:0 nt
    global_load_dwordx4 v[124:127], v9, s[20:21] offset:1152 nt
    global_load_dwordx4 v[128:131], v9, s[20:21] offset:2304 nt
    global_load_dwordx4 v[132:135], v9, s[20:21] offset:3456 nt
L_w4e:
    v_and_b32 v9, 6, v20
    v_mad_u32_u24 v9, v9, 3, v20
    v_mul_u32_u24 v9, 1152, v9
    v_add3_u32 v9, v9, v22, s45
    v_mov_b32 v72, 0
    v_mov_b32 v73, 0
    v_mov_b32 v74, 0
    v_mov_b32 v75, 0
    v_mov_b32 v76, 0
    v_mov_b32 v77, 0
    v_mov_b32 v78, 0
    v_mov_b32 v79, 0
    v_mov_b32 v80, 0
    v_mov_b32 v81, 0
    v_mov_b32 v82, 0
    v_mov_b32 v83, 0
    v_mov_b32 v84, 0
    v_mov_b32 v85, 0
    v_mov_b32 v86, 0
    v_mov_b32 v87, 0
    s_bitcmp1_b32 s33, 0
    s_cbranch_scc1 L_w4f
    global_load_dwordx4 v[72:75], v9, s[12:13] nt
    v_add_u32 v9, 2304, v9
    global_load_dwordx4 v[76:79], v9, s[12:13] nt
    s_branch L_w4g
L_w4f:
    v_add_u32 v9, 4608, v9
    global_load_dwordx4 v[80:83], v9, s[12:13] nt
    v_add_u32 v9, 2304, v9
    global_load_dwordx4 v[84:87], v9, s[12:13] nt
L_w4g:
    v_mov_b32 v48, 0
    v_mov_b32 v49, 0
    v_mov_b32 v50, 0
    v_mov_b32 v51, 0
    s_waitcnt vmcnt(2)
L_w4h:
    s_branch C_29
P_27:
    global_load_dwordx4 v[52:55], v160, s[28:29] sc1
    s_waitcnt vmcnt(0)
C_29:
    v_cmp_eq_u32 vcc, s36, v55
    s_cmp_eq_u64 vcc, -1
    s_cbranch_scc1 D_28
    s_sub_u32 s37, s37, 1
    s_cbranch_scc0 P_27
    s_mov_b32 s37, 0
D_28:
    v_perm_b32 v55, v53, v52, s62
    v_lshl_or_b32 v55, v54, 24, v55
    s_mov_b32 s69, s68
    v_cndmask_b32 v52, 0, v52, s[68:69]
    v_cndmask_b32 v53, 0, v53, s[68:69]
    v_cndmask_b32 v54, 0, v54, s[68:69]
    v_cndmask_b32 v55, 0, v55, s[68:69]
    v_add_f32_dpp v52, v52, v52 quad_perm:[1,0,3,2] row_mask:0xf bank_mask:0xf
    v_add_f32_dpp v53, v53, v53 quad_perm:[1,0,3,2] row_mask:0xf bank_mask:0xf
    v_add_f32_dpp v54, v54, v54 quad_perm:[1,0,3,2] row_mask:0xf bank_mask:0xf
    v_add_f32_dpp v55, v55, v55 quad_perm:[1,0,3,2] row_mask:0xf bank_mask:0xf
    v_add_f32_dpp v52, v52, v52 quad_perm:[2,3,0,1] row_mask:0xf bank_mask:0xf
    v_add_f32_dpp v53, v53, v53 quad_perm:[2,3,0,1] row_mask:0xf bank_mask:0xf
    v_add_f32_dpp v54, v54, v54 quad_perm:[2,3,0,1] row_mask:0xf bank_mask:0xf
    v_add_f32_dpp v55, v55, v55 quad_perm:[2,3,0,1] row_mask:0xf bank_mask:0xf
L_hop0:
    s_cbranch_execz L_hret
    v_add_f32_dpp v52, v52, v52 row_half_mirror row_mask:0xf bank_mask:0xf
    v_add_f32_dpp v53, v53, v53 row_half_mirror row_mask:0xf bank_mask:0xf
    v_add_f32_dpp v54, v54, v54 row_half_mirror row_mask:0xf bank_mask:0xf
    v_add_f32_dpp v55, v55, v55 row_half_mirror row_mask:0xf bank_mask:0xf
    v_cvt_pk_bf16_f32 v52, v52, v53
    v_lshlrev_b32 v10, 16, v26
    v_and_b32 v11, 0xffff0000, v26
    v_and_b32 v53, 0xffff0000, v52
    v_lshlrev_b32 v52, 16, v52
    v_add_f32 v52, v52, v10
    v_add_f32 v53, v53, v11
    v_cvt_pk_bf16_f32 v52, v52, v53
    v_and_b32 v53, 0xffff0000, v52
    v_lshlrev_b32 v52, 16, v52
    v_cvt_pk_bf16_f32 v54, v54, v55
    v_lshlrev_b32 v10, 16, v27
    v_and_b32 v11, 0xffff0000, v27
    v_and_b32 v55, 0xffff0000, v54
    v_lshlrev_b32 v54, 16, v54
    v_add_f32 v54, v54, v10
    v_add_f32 v55, v55, v11
    v_cvt_pk_bf16_f32 v54, v54, v55
    v_and_b32 v55, 0xffff0000, v54
    v_lshlrev_b32 v54, 16, v54
    s_mov_b32 s38, 0xbdd2d3e8
    s_mov_b32 s39, 0xc0135761
    v_mul_f32 v10, v52, v52
    v_mul_f32 v11, v53, v53
    v_mul_f32 v12, v54, v54
    v_mul_f32 v13, v55, v55
    v_mul_f32 v10, s38, v10
    v_mul_f32 v11, s38, v11
    v_mul_f32 v12, s38, v12
    v_mul_f32 v13, s38, v13
    v_add_f32 v10, s39, v10
    v_add_f32 v11, s39, v11
    v_add_f32 v12, s39, v12
    v_add_f32 v13, s39, v13
    v_mul_f32 v10, v52, v10
    v_mul_f32 v11, v53, v11
    v_mul_f32 v12, v54, v12
    v_mul_f32 v13, v55, v13
    v_exp_f32 v10, v10
    v_exp_f32 v11, v11
    v_exp_f32 v12, v12
    v_exp_f32 v13, v13
    v_add_f32 v10, 1.0, v10
    v_add_f32 v11, 1.0, v11
    v_add_f32 v12, 1.0, v12
    v_add_f32 v13, 1.0, v13
    v_rcp_f32 v10, v10
    v_rcp_f32 v11, v11
    v_rcp_f32 v12, v12
    v_rcp_f32 v13, v13
    v_mul_f32 v10, v52, v10
    v_mul_f32 v11, v53, v11
    v_mul_f32 v12, v54, v12
    v_mul_f32 v13, v55, v13
    v_cvt_pk_bf16_f32 v28, v10, v10
    v_cvt_pk_bf16_f32 v29, v11, v11
    v_cvt_pk_bf16_f32 v30, v12, v12
    v_cvt_pk_bf16_f32 v31, v13, v13
    v_and_b32 v32, v28, v4
    v_and_b32 v33, v28, v5
    v_and_b32 v34, v28, v6
    v_and_b32 v35, v28, v7
    s_nop 1
    v_mfma_f32_16x16x32_bf16 v[48:51], v[56:59], v[32:35], v[48:51]
    v_and_b32 v36, v29, v4
    v_and_b32 v37, v29, v5
    v_and_b32 v38, v29, v6
    v_and_b32 v39, v29, v7
    s_nop 1
    v_mfma_f32_16x16x32_bf16 v[48:51], v[60:63], v[36:39], v[48:51]
    v_and_b32 v40, v30, v4
    v_and_b32 v41, v30, v5
    v_and_b32 v42, v30, v6
    v_and_b32 v43, v30, v7
    s_nop 1
    v_mfma_f32_16x16x32_bf16 v[48:51], v[64:67], v[40:43], v[48:51]
    v_and_b32 v44, v31, v4
    v_and_b32 v45, v31, v5
    v_and_b32 v46, v31, v6
    v_and_b32 v47, v31, v7
    s_nop 1
    v_mfma_f32_16x16x32_bf16 v[48:51], v[68:71], v[44:47], v[48:51]
    s_cmp_lg_u32 s63, 2
    s_cbranch_scc1 L_w4i
    s_mov_b32 s63, 0
    s_mov_b32 s68, s40
    v_mov_b32 v52, v216
    v_mov_b32 v53, v217
    v_mov_b32 v54, v218
    v_mov_b32 v55, v219
    v_mov_b32 v26, v220
    v_mov_b32 v27, v221
    v_mov_b32 v160, v225
    v_mov_b32 v56, v120
    v_mov_b32 v57, v121
    v_mov_b32 v58, v122
    v_mov_b32 v59, v123
    v_mov_b32 v60, v124
    v_mov_b32 v61, v125
    v_mov_b32 v62, v126
    v_mov_b32 v63, v127
    v_mov_b32 v64, v128
    v_mov_b32 v65, v129
    v_mov_b32 v66, v130
    v_mov_b32 v67, v131
    v_mov_b32 v68, v132
    v_mov_b32 v69, v133
    v_mov_b32 v70, v134
    v_mov_b32 v71, v135
    s_branch L_w4h
L_w4i:
    v_add_u32 v12, s52, v14
    s_mov_b64 exec, s[26:27]
    s_nop 3
    v_cvt_f64_f32 v[32:33], v48
    ds_add_f64 v12, v[32:33] offset:2048
    v_cvt_f64_f32 v[34:35], v49
    ds_add_f64 v12, v[34:35] offset:2112
    v_cvt_f64_f32 v[36:37], v50
    ds_add_f64 v12, v[36:37] offset:2176
    v_cvt_f64_f32 v[38:39], v51
    ds_add_f64 v12, v[38:39] offset:2240
    s_mov_b64 exec, -1
    s_cmp_lt_u32 s2, 36
    s_cselect_b32 s43, 1, 0
P_30:
    ds_read_b32 v10, v3 offset:24
    s_waitcnt lgkmcnt(0)
    v_readfirstlane_b32 s3, v10
    s_cmp_ge_u32 s3, 4
    s_cbranch_scc1 D_31
    s_sub_u32 s37, s37, 1
    s_cbranch_scc0 P_30
    s_mov_b32 s37, 0
D_31:
    s_branch L_st
L_str:
    s_sub_u32 s1, s66, 25
    s_mov_b32 s0, 99
    v_add_u32 v234, s43, v16
    v_lshrrev_b32 v11, 4, v1
    v_bfe_u32 v12, v1, 2, 1
    v_lshlrev_b32 v235, 8, v12
    v_and_b32 v12, 1, v1
    v_lshl_add_u32 v235, v12, 6, v235
    v_lshl_add_u32 v235, v11, 4, v235
    v_bfe_u32 v12, v1, 4, 1
    s_lshl_b32 s38, s34, 3
    v_lshl_add_u32 v238, v12, 5, s38
    s_lshl_b32 s38, s34, 9
    s_add_u32 s38, s38, 10752
    v_lshl_add_u32 v236, v12, 8, s38
    v_and_b32 v12, 3, v1
    v_lshl_add_u32 v236, v12, 6, v236
    v_lshrrev_b32 v12, 5, v1
    v_lshl_add_u32 v236, v12, 4, v236
    v_bfe_u32 v12, v1, 2, 2
    v_lshl_add_u32 v236, v12, 2, v236
    v_and_b32 v12, 1, v20
    v_lshl_add_u32 v237, v12, 8, s38
    v_lshl_add_u32 v237, v11, 6, v237
    v_lshlrev_b32 v239, 5, v12
    v_lshrrev_b32 v240, 1, v22
    v_lshl_add_u32 v240, v12, 8, v240
    v_lshl_add_u32 v240, v11, 6, v240
    s_lshl_b32 s47, s47, 10
    s_add_u32 s47, s47, 524288
    s_mov_b32 s43, 0
    s_cmp_gt_u32 s0, 10
    s_cbranch_scc1 L_w10_0
    s_waitcnt vmcnt(4)
L_w10_0:
    s_waitcnt vmcnt(7)
    global_load_dwordx4 v[96:99], v9, s[6:7] offset:0 nt
    s_cmp_gt_u32 s0, 11
    s_cbranch_scc1 L_w11_0
    s_waitcnt vmcnt(4)
L_w11_0:
    s_waitcnt vmcnt(7)
    global_load_dwordx4 v[100:103], v9, s[6:7] offset:128 nt
    s_load_dword s64, s[28:29], 1024
    s_memrealtime s[66:67]
    s_waitcnt lgkmcnt(0)
    s_sub_u32 s0, s66, s1
    s_cmp_gt_u32 s0, 211
    s_cselect_b32 s0, 99, 0
    s_cmp_gt_u32 s0, 12
    s_cbranch_scc1 L_w12_0
    s_waitcnt vmcnt(4)
L_w12_0:
    s_waitcnt vmcnt(7)
    v_xor_b32 v9, 0x4000, v23
    global_load_dwordx4 v[104:107], v9, s[6:7] offset:0 nt
    s_cmp_gt_u32 s0, 13
    s_cbranch_scc1 L_w13_0
    s_waitcnt vmcnt(4)
L_w13_0:
    s_waitcnt vmcnt(7)
    global_load_dwordx4 v[108:111], v9, s[6:7] offset:128 nt
    s_memrealtime s[66:67]
    s_waitcnt lgkmcnt(0)
    s_sub_u32 s0, s1, s64
L_nohop4:
    s_nop 0
    s_add_u32 s0, s0, 75
    s_cmp_lt_u32 s0, 250
    s_cselect_b32 s1, s64, s1
    s_waitcnt lgkmcnt(0)
    s_sub_u32 s0, s66, s1
    s_cmp_gt_u32 s0, 242
    s_cselect_b32 s0, 99, 0
    s_cmp_gt_u32 s0, 14
    s_cbranch_scc1 L_w14_0
    s_waitcnt vmcnt(4)
L_w14_0:
    s_waitcnt vmcnt(7)
    v_xor_b32 v9, 0x6000, v23
    global_load_dwordx4 v[112:115], v9, s[6:7] offset:0 nt
    s_lshl_b32 s38, s48, 2
    v_lshl_add_u32 v11, v20, 4, s38
P_1:
    ds_read_b32 v10, v3 offset:0
    ds_read_b128 v[152:155], v11 offset:5120
    s_waitcnt lgkmcnt(0)
    v_readfirstlane_b32 s3, v10
    s_cmp_lg_u32 s3, 0
    s_cbranch_scc1 D_2
    s_sub_u32 s37, s37, 1
    s_cbranch_scc0 P_1
    s_mov_b32 s37, 0
D_2:
    s_waitcnt vmcnt(7)
    v_and_b32 v32, v152, v4
    v_and_b32 v33, v152, v5
    v_and_b32 v34, v152, v6
    v_and_b32 v35, v152, v7
    s_nop 1
    v_mfma_f32_16x16x32_bf16 v[48:51], v[56:59], v[32:35], 0
    v_and_b32 v36, v153, v4
    v_and_b32 v37, v153, v5
    v_and_b32 v38, v153, v6
    v_and_b32 v39, v153, v7
    s_nop 1
    v_mfma_f32_16x16x32_bf16 v[48:51], v[60:63], v[36:39], v[48:51]
    v_and_b32 v40, v154, v4
    v_and_b32 v41, v154, v5
    v_and_b32 v42, v154, v6
    v_and_b32 v43, v154, v7
    s_nop 1
    v_mfma_f32_16x16x32_bf16 v[48:51], v[64:67], v[40:43], v[48:51]
    v_and_b32 v44, v155, v4
    v_and_b32 v45, v155, v5
    v_and_b32 v46, v155, v6
    v_and_b32 v47, v155, v7
    s_nop 1
    v_mfma_f32_16x16x32_bf16 v[48:51], v[68:71], v[44:47], v[48:51]
    s_mov_b64 exec, s[26:27]
    s_nop 6
    v_cvt_f64_f32 v[32:33], v48
    ds_add_f64 v14, v[32:33] offset:512
    v_cvt_f64_f32 v[34:35], v49
    ds_add_f64 v14, v[34:35] offset:576
    v_cvt_f64_f32 v[36:37], v50
    ds_add_f64 v14, v[36:37] offset:640
    v_cvt_f64_f32 v[38:39], v51
    ds_add_f64 v14, v[38:39] offset:704
    s_mov_b64 exec, 1
    ds_add_u32 v3, v8 offset:16
    s_mov_b64 exec, -1
    s_cmp_gt_u32 s0, 15
    s_cbranch_scc1 L_w15_0
    s_waitcnt vmcnt(4)
L_w15_0:
    global_load_dwordx4 v[116:119], v9, s[6:7] offset:128 nt
    s_memrealtime s[66:67]
    s_waitcnt lgkmcnt(0)
    s_sub_u32 s0, s66, s1
    s_cmp_gt_u32 s0, 273
    s_cselect_b32 s0, 99, 0
    s_cmp_gt_u32 s0, 16
    s_cbranch_scc1 L_w16_0
    s_waitcnt vmcnt(4)
L_w16_0:
    s_waitcnt vmcnt(7)
    v_xor_b32 v9, 0x8000, v23
    global_load_dwordx4 v[120:123], v9, s[6:7] offset:0 nt
    s_lshl_b32 s38, s50, 7
    v_lshl_add_u32 v11, v20, 4, s38
P_3:
    ds_read_b32 v10, v3 offset:4
    ds_read_b128 v[152:155], v11 offset:7680
    s_waitcnt lgkmcnt(0)
    v_readfirstlane_b32 s3, v10
    s_cmp_lg_u32 s3, 0
    s_cbranch_scc1 D_4
    s_sub_u32 s37, s37, 1
    s_cbranch_scc0 P_3
    s_mov_b32 s37, 0
D_4:
    v_and_b32 v32, v152, v4
    v_and_b32 v33, v152, v5
    v_and_b32 v34, v152, v6
    v_and_b32 v35, v152, v7
    s_nop 1
    v_mfma_f32_16x16x32_bf16 v[48:51], v[72:75], v[32:35], 0
    v_and_b32 v36, v153, v4
    v_and_b32 v37, v153, v5
    v_and_b32 v38, v153, v6
    v_and_b32 v39, v153, v7
    s_nop 1
    v_mfma_f32_16x16x32_bf16 v[48:51], v[76:79], v[36:39], v[48:51]
    v_and_b32 v40, v154, v4
    v_and_b32 v41, v154, v5
    v_and_b32 v42, v154, v6
    v_and_b32 v43, v154, v7
    s_nop 1
    v_mfma_f32_16x16x32_bf16 v[48:51], v[80:83], v[40:43], v[48:51]
    v_and_b32 v44, v155, v4
    v_and_b32 v45, v155, v5
    v_and_b32 v46, v155, v6
    v_and_b32 v47, v155, v7
    s_nop 1
    v_mfma_f32_16x16x32_bf16 v[48:51], v[84:87], v[44:47], v[48:51]
    v_add_u32 v11, s49, v14
    s_mov_b64 exec, s[26:27]
    s_nop 5
    v_cvt_f64_f32 v[32:33], v48
    ds_add_f64 v11, v[32:33] offset:1024
    v_cvt_f64_f32 v[34:35], v49
    ds_add_f64 v11, v[34:35] offset:1088
    v_cvt_f64_f32 v[36:37], v50
    ds_add_f64 v11, v[36:37] offset:1152
    v_cvt_f64_f32 v[38:39], v51
    ds_add_f64 v11, v[38:39] offset:1216
    s_mov_b64 exec, 1
    ds_add_u32 v3, v8 offset:20
    s_mov_b64 exec, -1
    s_cmp_gt_u32 s0, 17
    s_cbranch_scc1 L_w17_0
    s_waitcnt vmcnt(4)
L_w17_0:
    s_waitcnt vmcnt(7)
    global_load_dwordx4 v[124:127], v9, s[6:7] offset:128 nt
    s_memrealtime s[66:67]
    s_waitcnt lgkmcnt(0)
    s_sub_u32 s0, s66, s1
    s_cmp_gt_u32 s0, 304
    s_cselect_b32 s0, 99, 0
    s_cmp_gt_u32 s0, 18
    s_cbranch_scc1 L_w18_0
    s_waitcnt vmcnt(4)
L_w18_0:
    s_waitcnt vmcnt(7)
    v_xor_b32 v9, 0xa000, v23
    global_load_dwordx4 v[128:131], v9, s[6:7] offset:0 nt
    s_cmp_gt_u32 s0, 19
    s_cbranch_scc1 L_w19_0
    s_waitcnt vmcnt(4)
L_w19_0:
    s_waitcnt vmcnt(7)
    global_load_dwordx4 v[132:135], v9, s[6:7] offset:128 nt
    s_memrealtime s[66:67]
    s_waitcnt lgkmcnt(0)
    s_sub_u32 s0, s66, s1
    s_cmp_gt_u32 s0, 335
    s_cselect_b32 s0, 99, 0
    s_cmp_gt_u32 s0, 20
    s_cbranch_scc1 L_w20_0
    s_waitcnt vmcnt(4)
L_w20_0:
    s_waitcnt vmcnt(7)
    v_xor_b32 v9, 0xc000, v23
    global_load_dwordx4 v[136:139], v9, s[6:7] offset:0 nt
    s_cmp_gt_u32 s0, 21
    s_cbranch_scc1 L_w21_0
    s_waitcnt vmcnt(4)
L_w21_0:
    s_waitcnt vmcnt(7)
    global_load_dwordx4 v[140:143], v9, s[6:7] offset:128 nt
    s_memrealtime s[66:67]
    s_waitcnt lgkmcnt(0)
    s_sub_u32 s0, s66, s1
    s_cmp_gt_u32 s0, 366
    s_cselect_b32 s0, 99, 0
    s_cmp_gt_u32 s0, 22
    s_cbranch_scc1 L_w22_0
    s_waitcnt vmcnt(4)
L_w22_0:
    s_waitcnt vmcnt(7)
    v_xor_b32 v9, 0xe000, v23
    global_load_dwordx4 v[144:147], v9, s[6:7] offset:0 nt
    s_cmp_gt_u32 s0, 23
    s_cbranch_scc1 L_w23_0
    s_waitcnt vmcnt(4)
L_w23_0:
    s_waitcnt vmcnt(7)
    global_load_dwordx4 v[148:151], v9, s[6:7] offset:128 nt
    s_memrealtime s[66:67]
    s_waitcnt lgkmcnt(0)
    s_sub_u32 s0, s66, s1
    s_cmp_gt_u32 s0, 397
    s_cselect_b32 s0, 99, 0
    s_cmp_gt_u32 s0, 24
    s_cbranch_scc1 L_w24_0
    s_waitcnt vmcnt(4)
L_w24_0:
    s_waitcnt vmcnt(7)
    global_load_dwordx4 v[164:167], v234, s[8:9] offset:0 nt
    s_cmp_gt_u32 s0, 25
    s_cbranch_scc1 L_w25_0
    s_waitcnt vmcnt(4)
L_w25_0:
    s_waitcnt vmcnt(7)
    global_load_dwordx4 v[168:171], v234, s[8:9] offset:1024 nt
    s_memrealtime s[66:67]
L_hop2:
    s_cbranch_execz L_hret
    s_waitcnt lgkmcnt(0)
    s_sub_u32 s0, s66, s1
    s_cmp_gt_u32 s0, 428
    s_cselect_b32 s0, 99, 0
    s_cmp_gt_u32 s0, 26
    s_cbranch_scc1 L_w26_0
    s_waitcnt vmcnt(4)
L_w26_0:
    v_xor_b32 v9, 0x2000, v234
    global_load_dwordx4 v[172:175], v9, s[8:9] offset:0 nt
    s_cmp_gt_u32 s0, 27
    s_cbranch_scc1 L_w27_0
    s_waitcnt vmcnt(4)
L_w27_0:
    s_waitcnt vmcnt(8)
    global_load_dwordx4 v[176:179], v9, s[8:9] offset:1024 nt
    s_memrealtime s[66:67]
    s_waitcnt lgkmcnt(0)
    s_sub_u32 s0, s66, s1
    s_cmp_gt_u32 s0, 459
    s_cselect_b32 s0, 99, 0
    s_cmp_gt_u32 s0, 28
    s_cbranch_scc1 L_w28_0
    s_waitcnt vmcnt(4)
L_w28_0:
    s_waitcnt vmcnt(8)
    v_xor_b32 v9, 0x4000, v234
    global_load_dwordx4 v[180:183], v9, s[8:9] offset:0 nt
    s_cmp_gt_u32 s0, 29
    s_cbranch_scc1 L_w29_0
    s_waitcnt vmcnt(4)
L_w29_0:
    s_waitcnt vmcnt(8)
    global_load_dwordx4 v[184:187], v9, s[8:9] offset:1024 nt
    s_memrealtime s[66:67]
    s_waitcnt lgkmcnt(0)
    s_sub_u32 s0, s66, s1
    s_cmp_gt_u32 s0, 490
    s_cselect_b32 s0, 99, 0
    s_cmp_gt_u32 s0, 30
    s_cbranch_scc1 L_w30_0
    s_waitcnt vmcnt(4)
L_w30_0:
    s_waitcnt vmcnt(8)
    v_xor_b32 v9, 0x6000, v234
    global_load_dwordx4 v[188:191], v9, s[8:9] offset:0 nt
    s_lshr_b32 s38, s53, 1
    s_lshr_b32 s39, 0x4a, s38
    s_and_b32 s39, s39, 1
    s_mul_i32 s68, s39, 0x10101010
    s_or_b32 s68, s68, 0x0f0f0f0f
    s_add_u32 s39, s39, 3
    s_lshl_b32 s39, s39, 4
    s_mul_i32 s38, s38, 4715
    s_lshr_b32 s38, s38, 10
    s_mul_i32 s14, s30, 40
    s_add_u32 s38, s38, s14
    s_and_b32 s14, s53, 1
    s_lshl1_add_u32 s38, s38, s14
    s_lshl_b32 s38, s38, 7
    s_add_u32 s38, s38, 262144
    v_min_u32 v160, s39, v22
    v_lshl_add_u32 v160, v160, 4, s38
    v_lshl_add_u32 v160, v20, 4, v160
    s_lshl_b32 s38, s53, 6
    s_add_u32 s38, s38, s42
    v_lshl_add_u32 v26, v20, 3, s38
    global_load_dwordx4 v[52:55], v160, s[28:29] sc1
    global_load_dwordx2 v[26:27], v26, s[18:19]
    s_cmp_gt_u32 s0, 31
    s_cbranch_scc1 L_w31_0
    s_waitcnt vmcnt(6)
L_w31_0:
    s_waitcnt vmcnt(10)
    global_load_dwordx4 v[192:195], v9, s[8:9] offset:1024 nt
    s_memrealtime s[66:67]
    s_waitcnt lgkmcnt(0)
    s_sub_u32 s0, s66, s1
    s_cmp_gt_u32 s0, 521
    s_cselect_b32 s0, 99, 0
    s_cmp_gt_u32 s0, 32
    s_cbranch_scc1 L_w32_0
    s_waitcnt vmcnt(6)
L_w32_0:
    s_waitcnt vmcnt(10)
    v_xor_b32 v9, 0x8000, v234
    global_load_dwordx4 v[196:199], v9, s[8:9] offset:0 nt
    s_cmp_gt_u32 s0, 33
    s_cbranch_scc1 L_w33_0
    s_waitcnt vmcnt(6)
L_w33_0:
    s_waitcnt vmcnt(10)
    global_load_dwordx4 v[200:203], v9, s[8:9] offset:1024 nt
    s_memrealtime s[66:67]
    s_waitcnt lgkmcnt(0)
    s_sub_u32 s0, s66, s1
    s_cmp_gt_u32 s0, 552
    s_cselect_b32 s0, 99, 0
    s_cmp_gt_u32 s0, 34
    s_cbranch_scc1 L_w34_0
    s_waitcnt vmcnt(6)
L_w34_0:
    s_waitcnt vmcnt(10)
    v_xor_b32 v9, 0xa000, v234
    global_load_dwordx4 v[204:207], v9, s[8:9] offset:0 nt
P_5:
    ds_read_b32 v10, v3 offset:8
    ds_read_b128 v[152:155], v235 offset:10240
    ds_read_b128 v[156:159], v235 offset:10368
    s_waitcnt lgkmcnt(0)
    v_readfirstlane_b32 s46, v10
    s_cmp_lg_u32 s46, 0
    s_cbranch_scc1 D_6
    s_sub_u32 s37, s37, 1
    s_cbranch_scc0 P_5
    s_mov_b32 s37, 0
D_6:
    v_mfma_f32_16x16x32_bf16 v[48:51], v[152:155], v[88:91], 0
    v_mfma_f32_16x16x32_bf16 v[48:51], v[156:159], v[92:95], v[48:51]
    v_mfma_f32_16x16x32_bf16 v[88:91], v[152:155], v[96:99], 0
    v_mfma_f32_16x16x32_bf16 v[88:91], v[156:159], v[100:103], v[88:91]
    v_mfma_f32_16x16x32_bf16 v[96:99], v[152:155], v[104:107], 0
    v_mfma_f32_16x16x32_bf16 v[96:99], v[156:159], v[108:111], v[96:99]
    v_mfma_f32_16x16x32_bf16 v[104:107], v[152:155], v[112:115], 0
    v_mfma_f32_16x16x32_bf16 v[104:107], v[156:159], v[116:119], v[104:107]
    s_cmp_gt_u32 s0, 35
    s_cbranch_scc1 L_w35_0
    s_waitcnt vmcnt(6)
L_w35_0:
    s_waitcnt vmcnt(10)
    global_load_dwordx4 v[208:211], v9, s[8:9] offset:1024 nt
    s_memrealtime s[66:67]
    v_mfma_f32_16x16x32_bf16 v[112:115], v[152:155], v[120:123], 0
    v_mfma_f32_16x16x32_bf16 v[112:115], v[156:159], v[124:127], v[112:115]
    v_mfma_f32_16x16x32_bf16 v[120:123], v[152:155], v[128:131], 0
    v_mfma_f32_16x16x32_bf16 v[120:123], v[156:159], v[132:135], v[120:123]
    v_mfma_f32_16x16x32_bf16 v[128:131], v[152:155], v[136:139], 0
    v_mfma_f32_16x16x32_bf16 v[128:131], v[156:159], v[140:143], v[128:131]
    v_mfma_f32_16x16x32_bf16 v[136:139], v[152:155], v[144:147], 0
    v_mfma_f32_16x16x32_bf16 v[136:139], v[156:159], v[148:151], v[136:139]
    s_waitcnt lgkmcnt(0)
    s_sub_u32 s0, s66, s1
    s_cmp_gt_u32 s0, 583
    s_cselect_b32 s0, 99, 0
    s_cmp_gt_u32 s0, 36
    s_cbranch_scc1 L_w36_0
    s_waitcnt vmcnt(4)
L_w36_0:
    s_waitcnt vmcnt(10)
    v_xor_b32 v9, 0xc000, v234
    global_load_dwordx4 v[212:215], v9, s[8:9] offset:0 nt
    v_add_f32_dpp v241, v49, v48 row_ror:8 row_mask:0x3 bank_mask:0x3
    s_nop 1
    v_add_f32_dpp v241, v88, v89 row_ror:8 row_mask:0x3 bank_mask:0xc
    s_nop 1
    v_add_f32_dpp v241, v97, v96 row_ror:8 row_mask:0xc bank_mask:0x3
    s_nop 1
    v_add_f32_dpp v241, v104, v105 row_ror:8 row_mask:0xc bank_mask:0xc
    v_add_f32_dpp v242, v113, v112 row_ror:8 row_mask:0x3 bank_mask:0x3
    s_nop 1
    v_add_f32_dpp v242, v120, v121 row_ror:8 row_mask:0x3 bank_mask:0xc
    s_nop 1
    v_add_f32_dpp v242, v129, v128 row_ror:8 row_mask:0xc bank_mask:0x3
    s_nop 1
    v_add_f32_dpp v242, v136, v137 row_ror:8 row_mask:0xc bank_mask:0xc
    v_cvt_pk_bf16_f32 v10, v241, v242
    v_lshlrev_b32 v241, 16, v10
    v_and_b32 v242, 0xffff0000, v10
    v_mul_f32 v241, 0x3db504f3, v241
    v_mul_f32 v242, 0x3db504f3, v242
    v_cvt_pk_bf16_f32 v10, v241, v242
    v_lshlrev_b32 v241, 16, v10
    v_and_b32 v242, 0xffff0000, v10
    v_mul_f32 v241, 0x3fb8aa3b, v241
    v_mul_f32 v242, 0x3fb8aa3b, v242
    v_max_f32 v232, v241, v242
    s_nop 1
    v_max_f32_dpp v232, v232, v232 row_ror:8 row_mask:0xf bank_mask:0xf
    s_nop 1
    v_max_f32_dpp v232, v232, v232 row_ror:4 row_mask:0xf bank_mask:0xf
    s_nop 1
    v_max_f32_dpp v232, v232, v232 row_ror:2 row_mask:0xf bank_mask:0xf
    s_nop 1
    v_max_f32_dpp v232, v232, v232 row_ror:1 row_mask:0xf bank_mask:0xf
L_nohop6:
    s_nop 0
    v_mov_b32 v10, v232
    s_nop 1
    v_permlane32_swap_b32 v232, v10
    v_max_f32 v232, v232, v10
    s_cmp_gt_u32 s0, 37
    s_cbranch_scc1 L_w37_0
    s_waitcnt vmcnt(4)
L_w37_0:
    s_waitcnt vmcnt(10)
    global_load_dwordx4 v[216:219], v9, s[8:9] offset:1024 nt
    s_memrealtime s[66:67]
    v_sub_f32 v241, v241, v232
    v_sub_f32 v242, v242, v232
    v_exp_f32 v241, v241
    v_exp_f32 v242, v242
    v_cvt_pk_bf16_f32 v10, v241, v241
    v_cvt_pk_bf16_f32 v11, v242, v242
    v_add_f32 v233, v241, v242
    ds_write2_b32 v236, v10, v11 offset0:0 offset1:8
    ds_read_b128 v[88:91], v237 offset:0
    ds_read_b128 v[92:95], v237 offset:16
    ds_read_b128 v[96:99], v237 offset:32
    ds_read_b128 v[100:103], v237 offset:48
    v_add_f32_dpp v233, v233, v233 row_ror:8 row_mask:0xf bank_mask:0xf
    s_nop 1
    v_add_f32_dpp v233, v233, v233 row_ror:4 row_mask:0xf bank_mask:0xf
    s_nop 1
    v_add_f32_dpp v233, v233, v233 row_ror:2 row_mask:0xf bank_mask:0xf
    s_nop 1
    v_add_f32_dpp v233, v233, v233 row_ror:1 row_mask:0xf bank_mask:0xf
    v_mov_b32 v12, v233
    s_nop 1
    v_permlane32_swap_b32 v233, v12
    v_add_f32 v233, v233, v12
    ds_write_b64 v238, v[232:233] offset:64
    s_waitcnt lgkmcnt(0)
    s_sub_u32 s0, s66, s1
    s_cmp_gt_u32 s0, 614
    s_cselect_b32 s0, 99, 0
    s_cmp_gt_u32 s0, 38
    s_cbranch_scc1 L_w38_0
    s_waitcnt vmcnt(4)
L_w38_0:
    s_waitcnt vmcnt(10)
    v_xor_b32 v9, 0xe000, v234
    global_load_dwordx4 v[220:223], v9, s[8:9] offset:0 nt
    s_waitcnt lgkmcnt(0)
    v_and_b32 v32, v88, v4
    v_and_b32 v33, v88, v5
    v_and_b32 v34, v88, v6
    v_and_b32 v35, v88, v7
    s_nop 1
    v_mfma_f32_16x16x32_bf16 v[228:231], v[164:167], v[32:35], 0
    v_and_b32 v36, v89, v4
    v_and_b32 v37, v89, v5
    v_and_b32 v38, v89, v6
    v_and_b32 v39, v89, v7
    s_nop 1
    v_mfma_f32_16x16x32_bf16 v[228:231], v[168:171], v[36:39], v[228:231]
    v_and_b32 v40, v90, v4
    v_and_b32 v41, v90, v5
    v_and_b32 v42, v90, v6
    v_and_b32 v43, v90, v7
    s_nop 1
    v_mfma_f32_16x16x32_bf16 v[228:231], v[172:175], v[40:43], v[228:231]
    s_cmp_gt_u32 s0, 39
    s_cbranch_scc1 L_w39_0
    s_waitcnt vmcnt(4)
L_w39_0:
    s_waitcnt vmcnt(10)
    global_load_dwordx4 v[224:227], v9, s[8:9] offset:1024 nt
    s_memrealtime s[66:67]
    v_and_b32 v44, v91, v4
    v_and_b32 v45, v91, v5
    v_and_b32 v46, v91, v6
    v_and_b32 v47, v91, v7
    s_nop 1
    v_mfma_f32_16x16x32_bf16 v[228:231], v[176:179], v[44:47], v[228:231]
    v_and_b32 v32, v92, v4
    v_and_b32 v33, v92, v5
    v_and_b32 v34, v92, v6
    v_and_b32 v35, v92, v7
    s_nop 1
    v_mfma_f32_16x16x32_bf16 v[228:231], v[180:183], v[32:35], v[228:231]
    v_and_b32 v36, v93, v4
    v_and_b32 v37, v93, v5
    v_and_b32 v38, v93, v6
    v_and_b32 v39, v93, v7
    s_nop 1
    v_mfma_f32_16x16x32_bf16 v[228:231], v[184:187], v[36:39], v[228:231]
    s_waitcnt lgkmcnt(0)
    s_sub_u32 s0, s66, s1
    s_cmp_gt_u32 s0, 645
    s_cselect_b32 s0, 99, 0
    s_cmp_gt_u32 s0, 40
    s_cbranch_scc1 L_w40_0
    s_waitcnt vmcnt(3)
L_w40_0:
    s_waitcnt vmcnt(8)
    s_mul_i32 s38, s53, 36864
    s_add_u32 s38, s38, s44
    v_mul_u32_u24 v9, 4608, v20
    v_add3_u32 v9, v9, v22, s38
    global_load_dwordx4 v[56:59], v9, s[20:21] offset:0 nt
    s_branch C_9
P_7:
    global_load_dwordx4 v[52:55], v160, s[28:29] sc1
    s_waitcnt vmcnt(0)
C_9:
    v_cmp_eq_u32 vcc, s36, v55
    s_cmp_eq_u64 vcc, -1
    s_cbranch_scc1 D_8
    s_sub_u32 s37, s37, 1
    s_cbranch_scc0 P_7
    s_mov_b32 s37, 0
D_8:
    v_perm_b32 v55, v53, v52, s62
    v_lshl_or_b32 v55, v54, 24, v55
    s_mov_b32 s69, s68
    v_cndmask_b32 v52, 0, v52, s[68:69]
    v_cndmask_b32 v53, 0, v53, s[68:69]
    v_cndmask_b32 v54, 0, v54, s[68:69]
    v_cndmask_b32 v55, 0, v55, s[68:69]
    v_add_f32_dpp v52, v52, v52 quad_perm:[1,0,3,2] row_mask:0xf bank_mask:0xf
    v_add_f32_dpp v53, v53, v53 quad_perm:[1,0,3,2] row_mask:0xf bank_mask:0xf
    v_add_f32_dpp v54, v54, v54 quad_perm:[1,0,3,2] row_mask:0xf bank_mask:0xf
    v_add_f32_dpp v55, v55, v55 quad_perm:[1,0,3,2] row_mask:0xf bank_mask:0xf
    v_add_f32_dpp v52, v52, v52 quad_perm:[2,3,0,1] row_mask:0xf bank_mask:0xf
    v_add_f32_dpp v53, v53, v53 quad_perm:[2,3,0,1] row_mask:0xf bank_mask:0xf
    v_add_f32_dpp v54, v54, v54 quad_perm:[2,3,0,1] row_mask:0xf bank_mask:0xf
    v_add_f32_dpp v55, v55, v55 quad_perm:[2,3,0,1] row_mask:0xf bank_mask:0xf
    v_add_f32_dpp v52, v52, v52 row_half_mirror row_mask:0xf bank_mask:0xf
    v_add_f32_dpp v53, v53, v53 row_half_mirror row_mask:0xf bank_mask:0xf
    v_add_f32_dpp v54, v54, v54 row_half_mirror row_mask:0xf bank_mask:0xf
    v_add_f32_dpp v55, v55, v55 row_half_mirror row_mask:0xf bank_mask:0xf
    v_cvt_pk_bf16_f32 v52, v52, v53
    v_lshlrev_b32 v10, 16, v26
    v_and_b32 v11, 0xffff0000, v26
    v_and_b32 v53, 0xffff0000, v52
    v_lshlrev_b32 v52, 16, v52
    v_add_f32 v52, v52, v10
    v_add_f32 v53, v53, v11
    v_cvt_pk_bf16_f32 v52, v52, v53
    v_and_b32 v53, 0xffff0000, v52
    v_lshlrev_b32 v52, 16, v52
    v_cvt_pk_bf16_f32 v54, v54, v55
    v_lshlrev_b32 v10, 16, v27
    v_and_b32 v11, 0xffff0000, v27
    v_and_b32 v55, 0xffff0000, v54
    v_lshlrev_b32 v54, 16, v54
    v_add_f32 v54, v54, v10
    v_add_f32 v55, v55, v11
    v_cvt_pk_bf16_f32 v54, v54, v55
    v_and_b32 v55, 0xffff0000, v54
    v_lshlrev_b32 v54, 16, v54
    v_and_b32 v40, v94, v4
    v_and_b32 v41, v94, v5
    v_and_b32 v42, v94, v6
    v_and_b32 v43, v94, v7
    s_nop 1
    v_mfma_f32_16x16x32_bf16 v[228:231], v[188:191], v[40:43], v[228:231]
    v_and_b32 v44, v95, v4
    v_and_b32 v45, v95, v5
    v_and_b32 v46, v95, v6
    v_and_b32 v47, v95, v7
    s_nop 1
    v_mfma_f32_16x16x32_bf16 v[228:231], v[192:195], v[44:47], v[228:231]
    s_cmp_gt_u32 s0, 41
    s_cbranch_scc1 L_w41_0
    s_waitcnt vmcnt(3)
L_w41_0:
    s_waitcnt vmcnt(8)
    global_load_dwordx4 v[60:63], v9, s[20:21] offset:1152 nt
    s_memrealtime s[66:67]
    s_mov_b32 s38, 0xbdd2d3e8
    s_mov_b32 s39, 0xc0135761
    v_mul_f32 v10, v52, v52
    v_mul_f32 v11, v53, v53
    v_mul_f32 v12, v54, v54
    v_mul_f32 v13, v55, v55
    v_mul_f32 v10, s38, v10
    v_mul_f32 v11, s38, v11
    v_mul_f32 v12, s38, v12
    v_mul_f32 v13, s38, v13
    v_add_f32 v10, s39, v10
    v_add_f32 v11, s39, v11
    v_add_f32 v12, s39, v12
    v_add_f32 v13, s39, v13
    v_mul_f32 v10, v52, v10
    v_mul_f32 v11, v53, v11
    v_mul_f32 v12, v54, v12
    v_mul_f32 v13, v55, v13
    v_exp_f32 v10, v10
    v_exp_f32 v11, v11
    v_exp_f32 v12, v12
    v_exp_f32 v13, v13
L_hop1:
    s_cbranch_execz L_hret
    v_add_f32 v10, 1.0, v10
    v_add_f32 v11, 1.0, v11
    v_add_f32 v12, 1.0, v12
    v_add_f32 v13, 1.0, v13
    v_rcp_f32 v10, v10
    v_rcp_f32 v11, v11
    v_rcp_f32 v12, v12
    v_rcp_f32 v13, v13
    v_mul_f32 v10, v52, v10
    v_mul_f32 v11, v53, v11
    v_mul_f32 v12, v54, v12
    v_mul_f32 v13, v55, v13
    v_cvt_pk_bf16_f32 v28, v10, v10
    v_cvt_pk_bf16_f32 v29, v11, v11
    v_cvt_pk_bf16_f32 v30, v12, v12
    v_cvt_pk_bf16_f32 v31, v13, v13
    v_and_b32 v32, v96, v4
    v_and_b32 v33, v96, v5
    v_and_b32 v34, v96, v6
    v_and_b32 v35, v96, v7
    s_nop 1
    v_mfma_f32_16x16x32_bf16 v[228:231], v[196:199], v[32:35], v[228:231]
    s_waitcnt lgkmcnt(0)
    s_sub_u32 s0, s66, s1
    s_cmp_gt_u32 s0, 676
    s_cselect_b32 s0, 99, 0
    s_cmp_gt_u32 s0, 42
    s_cbranch_scc1 L_w42_0
    s_waitcnt vmcnt(3)
L_w42_0:
    s_waitcnt vmcnt(8)
    global_load_dwordx4 v[64:67], v9, s[20:21] offset:2304 nt
    s_lshl_b32 s38, s34, 3
    v_add_u32 v11, s38, v239
    v_add_u32 v23, s47, v16
    v_lshrrev_b32 v241, 1, v16
P_10:
    ds_read_b128 v[152:155], v239 offset:64
    ds_read_b128 v[156:159], v239 offset:80
    ds_read_b32 v243, v11 offset:64
    s_waitcnt lgkmcnt(0)
    v_min_u32 v10, v153, v155
    v_min3_u32 v10, v10, v157, v159
    v_cmp_ne_u32 vcc, 0, v10
    s_cmp_eq_u64 vcc, -1
    s_cbranch_scc1 D_11
    s_sub_u32 s37, s37, 1
    s_cbranch_scc0 P_10
    s_mov_b32 s37, 0
D_11:
    v_max_f32 v10, v152, v154
    v_max3_f32 v10, v10, v156, v158
    v_sub_f32 v243, v243, v10
    v_exp_f32 v243, v243
    v_and_b32 v36, v97, v4
    v_and_b32 v37, v97, v5
    v_and_b32 v38, v97, v6
    v_and_b32 v39, v97, v7
    s_nop 1
    v_mfma_f32_16x16x32_bf16 v[228:231], v[200:203], v[36:39], v[228:231]
    s_cmp_gt_u32 s0, 43
    s_cbranch_scc1 L_w43_0
    s_waitcnt vmcnt(3)
L_w43_0:
    s_waitcnt vmcnt(8)
    global_load_dwordx4 v[68:71], v9, s[20:21] offset:3456 nt
    s_memrealtime s[66:67]
    v_and_b32 v40, v98, v4
    v_and_b32 v41, v98, v5
    v_and_b32 v42, v98, v6
    v_and_b32 v43, v98, v7
    s_nop 1
    v_mfma_f32_16x16x32_bf16 v[228:231], v[204:207], v[40:43], v[228:231]
    s_waitcnt lgkmcnt(0)
    s_sub_u32 s0, s66, s1
    s_cmp_gt_u32 s0, 737
    s_cselect_b32 s48, 99, 0
    s_cbranch_scc0 L_tn
    v_and_b32 v9, 6, v20
    v_mad_u32_u24 v9, v9, 3, v20
    v_mul_u32_u24 v9, 1152, v9
    v_add3_u32 v9, v9, v22, s45
    global_load_dwordx4 v[72:75], v9, s[12:13] offset:0 nt
    global_load_dwordx4 v[76:79], v9, s[12:13] offset:2304 nt
    v_add_u32 v9, 4608, v9
    global_load_dwordx4 v[80:83], v9, s[12:13] offset:0 nt
    global_load_dwordx4 v[84:87], v9, s[12:13] offset:2304 nt
L_tn:
    v_and_b32 v44, v99, v4
    v_and_b32 v45, v99, v5
    v_and_b32 v46, v99, v6
    v_and_b32 v47, v99, v7
    s_waitcnt vmcnt(12)
    s_cmp_lg_u32 s48, 0
    s_cbranch_scc1 X_12
    s_waitcnt vmcnt(8)
X_12:
    v_mfma_f32_16x16x32_bf16 v[228:231], v[208:211], v[44:47], v[228:231]
    v_and_b32 v32, v100, v4
    v_and_b32 v33, v100, v5
    v_and_b32 v34, v100, v6
    v_and_b32 v35, v100, v7
    s_waitcnt vmcnt(11)
    s_cmp_lg_u32 s48, 0
    s_cbranch_scc1 X_13
    s_waitcnt vmcnt(7)
X_13:
    v_mfma_f32_16x16x32_bf16 v[228:231], v[212:215], v[32:35], v[228:231]
    v_and_b32 v36, v101, v4
    v_and_b32 v37, v101, v5
    v_and_b32 v38, v101, v6
    v_and_b32 v39, v101, v7
    s_waitcnt vmcnt(10)
    s_cmp_lg_u32 s48, 0
    s_cbranch_scc1 X_14
    s_waitcnt vmcnt(6)
X_14:
    v_mfma_f32_16x16x32_bf16 v[228:231], v[216:219], v[36:39], v[228:231]
    v_and_b32 v40, v102, v4
    v_and_b32 v41, v102, v5
    v_and_b32 v42, v102, v6
    v_and_b32 v43, v102, v7
    s_waitcnt vmcnt(9)
    s_cmp_lg_u32 s48, 0
    s_cbranch_scc1 X_15
    s_waitcnt vmcnt(5)
X_15:
    v_mfma_f32_16x16x32_bf16 v[228:231], v[220:223], v[40:43], v[228:231]
    v_and_b32 v44, v103, v4
    v_and_b32 v45, v103, v5
    v_and_b32 v46, v103, v6
    v_and_b32 v47, v103, v7
    s_waitcnt vmcnt(8)
    s_cmp_lg_u32 s48, 0
    s_cbranch_scc1 X_16
    s_waitcnt vmcnt(4)
X_16:
    v_mfma_f32_16x16x32_bf16 v[228:231], v[224:227], v[44:47], v[228:231]
    s_nop 7
    v_mul_f32 v228, v228, v243
    v_mul_f32 v229, v229, v243
    v_mul_f32 v230, v230, v243
    v_mul_f32 v231, v231, v243
    v_cvt_f64_f32 v[32:33], v228
    ds_add_f64 v240, v[32:33] offset:3072
    v_cvt_f64_f32 v[34:35], v229
    ds_add_f64 v240, v[34:35] offset:3584
    v_cvt_f64_f32 v[36:37], v230
    ds_add_f64 v240, v[36:37] offset:4096
    v_cvt_f64_f32 v[38:39], v231
    ds_add_f64 v240, v[38:39] offset:4608
    s_mov_b64 exec, 1
    ds_add_rtn_u32 v161, v3, v8 offset:24
    s_mov_b64 exec, -1
    ds_read2st64_b64 v[152:155], v241 offset0:6 offset1:7
    ds_read2st64_b64 v[156:159], v241 offset0:8 offset1:9
    s_waitcnt lgkmcnt(0)
    v_readfirstlane_b32 s3, v161
    s_cmp_lg_u32 s3, 3
    s_cbranch_scc1 NP_17
    v_cvt_f32_f64 v152, v[152:153]
    v_cvt_f32_f64 v153, v[154:155]
    v_cvt_f32_f64 v154, v[156:157]
    v_cvt_f32_f64 v155, v[158:159]
    v_perm_b32 v152, v152, v155, s59
    v_perm_b32 v153, v153, v155, s60
    v_perm_b32 v154, v154, v155, s61
    v_mov_b32 v155, s36
    global_store_dwordx4 v23, v[152:155], s[28:29]
    s_cmp_lt_u32 s46, 2
    s_cbranch_scc1 NP_17
    global_store_dwordx4 v23, v[152:155], s[28:29] sc1
NP_17:
    s_cmp_lg_u32 s48, 0
    s_cbranch_scc1 L_tw
    s_memrealtime s[66:67]
    s_waitcnt lgkmcnt(0)
    s_sub_u32 s0, s66, s1
    s_cmp_gt_u32 s0, 707
    s_cselect_b32 s0, 99, 0
    s_cmp_gt_u32 s0, 44
    s_cbranch_scc1 L_w44_0
    s_waitcnt vmcnt(3)
L_w44_0:
    v_and_b32 v9, 6, v20
    v_mad_u32_u24 v9, v9, 3, v20
    v_mul_u32_u24 v9, 1152, v9
    v_add3_u32 v9, v9, v22, s45
    global_load_dwordx4 v[72:75], v9, s[12:13] offset:0 nt
    s_cmp_gt_u32 s0, 45
    s_cbranch_scc1 L_w45_0
    s_waitcnt vmcnt(3)
L_w45_0:
    global_load_dwordx4 v[76:79], v9, s[12:13] offset:2304 nt
    s_memrealtime s[66:67]
    s_waitcnt lgkmcnt(0)
    s_sub_u32 s0, s66, s1
    s_cmp_gt_u32 s0, 738
    s_cselect_b32 s0, 99, 0
    s_cmp_gt_u32 s0, 46
    s_cbranch_scc1 L_w46_0
    s_waitcnt vmcnt(3)
L_w46_0:
    v_add_u32 v9, 4608, v9
    global_load_dwordx4 v[80:83], v9, s[12:13] offset:0 nt
    s_cmp_gt_u32 s0, 47
    s_cbranch_scc1 L_w47_0
    s_waitcnt vmcnt(3)
L_w47_0:
    global_load_dwordx4 v[84:87], v9, s[12:13] offset:2304 nt
L_tw:
    global_load_dwordx3 v[112:114], v18, s[28:29] sc1
L_hop3:
    s_cbranch_execz L_hret
    global_load_dwordx3 v[116:118], v18, s[28:29] offset:128 sc1
    v_and_b32 v32, v28, v4
    v_and_b32 v33, v28, v5
    v_and_b32 v34, v28, v6
    v_and_b32 v35, v28, v7
    v_and_b32 v36, v29, v4
    v_and_b32 v37, v29, v5
    v_and_b32 v38, v29, v6
    v_and_b32 v39, v29, v7
    v_and_b32 v40, v30, v4
    v_and_b32 v41, v30, v5
    v_and_b32 v42, v30, v6
    v_and_b32 v43, v30, v7
    v_and_b32 v44, v31, v4
    v_and_b32 v45, v31, v5
    v_and_b32 v46, v31, v6
    v_and_b32 v47, v31, v7
    v_add_u32 v12, s52, v14
    s_waitcnt vmcnt(9)
    v_mfma_f32_16x16x32_bf16 v[48:51], v[56:59], v[32:35], 0
    s_waitcnt vmcnt(8)
    v_mfma_f32_16x16x32_bf16 v[48:51], v[60:63], v[36:39], v[48:51]
    s_waitcnt vmcnt(7)
    v_mfma_f32_16x16x32_bf16 v[48:51], v[64:67], v[40:43], v[48:51]
    s_waitcnt vmcnt(6)
    v_mfma_f32_16x16x32_bf16 v[48:51], v[68:71], v[44:47], v[48:51]
    s_mov_b64 exec, s[26:27]
    s_nop 6
    v_cvt_f64_f32 v[32:33], v48
    ds_add_f64 v12, v[32:33] offset:2048
    v_cvt_f64_f32 v[34:35], v49
    ds_add_f64 v12, v[34:35] offset:2112
    v_cvt_f64_f32 v[36:37], v50
    ds_add_f64 v12, v[36:37] offset:2176
    v_cvt_f64_f32 v[38:39], v51
    ds_add_f64 v12, v[38:39] offset:2240
    s_mov_b64 exec, -1
    s_waitcnt vmcnt(4)
    global_load_dwordx4 v[104:107], v17, s[28:29] sc1
    global_load_dwordx4 v[108:111], v17, s[28:29] offset:1024 sc1
    s_waitcnt vmcnt(2)
    v_cmp_eq_u32 s[66:67], s36, v114
    v_cmp_eq_u32 s[64:65], s36, v118
    s_and_b64 s[66:67], s[66:67], s[64:65]
    v_max_f32 v10, v112, v116
    s_nop 1
    v_max_f32_dpp v10, v10, v10 row_ror:8 row_mask:0xf bank_mask:0xf
    v_mov_b32 v11, v10
    s_nop 1
    v_permlane16_swap_b32 v10, v11
    v_max_f32 v10, v10, v11
    v_mov_b32 v11, v10
    s_nop 1
    v_permlane32_swap_b32 v10, v11
    v_max_f32 v10, v10, v11
    v_sub_f32 v24, v112, v10
    v_sub_f32 v25, v116, v10
    v_exp_f32 v24, v24
    v_exp_f32 v25, v25
    v_mul_f32 v11, v24, v113
    v_fmac_f32 v11, v25, v117
    s_nop 1
    v_add_f32_dpp v11, v11, v11 row_ror:8 row_mask:0xf bank_mask:0xf
    v_mov_b32 v10, v11
    s_nop 1
    v_permlane16_swap_b32 v11, v10
    v_add_f32 v11, v11, v10
    v_mov_b32 v10, v11
    s_nop 1
    v_permlane32_swap_b32 v11, v10
    v_add_f32 v11, v11, v10
    v_rcp_f32 v11, v11
    s_nop 0
    v_mul_f32 v24, v24, v11
    v_mul_f32 v25, v25, v11
    s_branch L_sc
L_st:
    global_load_dwordx3 v[112:114], v18, s[28:29] sc1
    global_load_dwordx3 v[116:118], v18, s[28:29] offset:128 sc1
    global_load_dwordx4 v[104:107], v17, s[28:29] sc1
    global_load_dwordx4 v[108:111], v17, s[28:29] offset:1024 sc1
    s_waitcnt vmcnt(2)
    v_cmp_eq_u32 s[66:67], s36, v114
    v_cmp_eq_u32 s[64:65], s36, v118
    s_and_b64 s[66:67], s[66:67], s[64:65]
    v_max_f32 v10, v112, v116
    s_nop 1
    v_max_f32_dpp v10, v10, v10 row_ror:8 row_mask:0xf bank_mask:0xf
    v_mov_b32 v11, v10
    s_nop 1
    v_permlane16_swap_b32 v10, v11
    v_max_f32 v10, v10, v11
    v_mov_b32 v11, v10
    s_nop 1
    v_permlane32_swap_b32 v10, v11
    v_max_f32 v10, v10, v11
    v_sub_f32 v24, v112, v10
    v_sub_f32 v25, v116, v10
    v_exp_f32 v24, v24
    v_exp_f32 v25, v25
    v_mul_f32 v11, v24, v113
    v_fmac_f32 v11, v25, v117
    s_nop 1
    v_add_f32_dpp v11, v11, v11 row_ror:8 row_mask:0xf bank_mask:0xf
    v_mov_b32 v10, v11
    s_nop 1
    v_permlane16_swap_b32 v11, v10
    v_add_f32 v11, v11, v10
    v_mov_b32 v10, v11
    s_nop 1
    v_permlane32_swap_b32 v11, v10
    v_add_f32 v11, v11, v10
    v_rcp_f32 v11, v11
    s_nop 0
    v_mul_f32 v24, v24, v11
    v_mul_f32 v25, v25, v11
L_sc:
    s_cmp_eq_u64 s[66:67], -1
    s_cbranch_scc1 L_to
    s_sub_u32 s37, s37, 1
    s_cbranch_scc0 L_st
    s_mov_b32 s37, 0
L_to:
    s_waitcnt vmcnt(0)
L_to2:
    v_cmp_ne_u32 vcc, s36, v107
    v_cmp_ne_u32 s[64:65], s36, v111
    s_or_b64 s[66:67], vcc, s[64:65]
    s_cbranch_scc0 L_td
    s_cbranch_vccz L_t1
    s_mov_b64 exec, vcc
    global_load_dwordx4 v[104:107], v17, s[28:29] sc1
L_t1:
    s_cmp_eq_u64 s[64:65], 0
    s_cbranch_scc1 L_t2
    s_mov_b64 exec, s[64:65]
    global_load_dwordx4 v[108:111], v17, s[28:29] offset:1024 sc1
L_t2:
    s_mov_b64 exec, -1
    s_sub_u32 s37, s37, 1
    s_cbranch_scc0 L_to
    s_mov_b32 s37, 0
    s_waitcnt vmcnt(0)
L_td:
    v_perm_b32 v10, v105, v104, s62
    v_lshl_or_b32 v10, v106, 24, v10
    v_perm_b32 v11, v109, v108, s62
    v_lshl_or_b32 v11, v110, 24, v11
    v_mul_f32 v28, v104, v24
    v_mul_f32 v29, v105, v24
    v_mul_f32 v30, v106, v24
    v_mul_f32 v31, v10, v24
    v_fmac_f32 v28, v108, v25
    v_fmac_f32 v29, v109, v25
    v_fmac_f32 v30, v110, v25
    v_fmac_f32 v31, v11, v25
    s_cmp_eq_u32 s43, 0
    s_cbranch_scc1 L_te
    global_load_dwordx4 v[88:91], v234, s[28:29] sc1
    global_load_dwordx4 v[92:95], v234, s[28:29] offset:256 sc1
    global_load_dwordx4 v[96:99], v235, s[28:29] sc1
L_te:
    v_permlane32_swap_b32 v28, v30
    v_permlane32_swap_b32 v29, v31
    v_add_f32 v28, v28, v30
    v_add_f32 v29, v29, v31
    s_nop 1
    v_permlane16_swap_b32 v28, v29
    v_add_f32 v10, v28, v29
    s_nop 1
    v_add_f32_dpp v10, v10, v10 row_ror:8 row_mask:0xf bank_mask:0xf
    v_cvt_pk_bf16_f32 v10, v10, v10
    s_nop 1
    v_mov_b32_dpp v28, v10 row_newbcast:0 row_mask:0xf bank_mask:0x3
    v_mov_b32_dpp v29, v10 row_newbcast:2 row_mask:0xf bank_mask:0x3
    v_mov_b32_dpp v30, v10 row_newbcast:4 row_mask:0xf bank_mask:0x3
    v_mov_b32_dpp v31, v10 row_newbcast:6 row_mask:0xf bank_mask:0x3
    v_mov_b32_dpp v28, v10 row_newbcast:1 row_mask:0xf bank_mask:0xc
    v_mov_b32_dpp v29, v10 row_newbcast:3 row_mask:0xf bank_mask:0xc
    v_mov_b32_dpp v30, v10 row_newbcast:5 row_mask:0xf bank_mask:0xc
    v_mov_b32_dpp v31, v10 row_newbcast:7 row_mask:0xf bank_mask:0xc
    v_and_b32 v32, v28, v4
    v_and_b32 v33, v28, v5
    v_and_b32 v34, v28, v6
    v_and_b32 v35, v28, v7
    s_nop 1
    v_mfma_f32_16x16x32_bf16 v[48:51], v[72:75], v[32:35], 0
    v_and_b32 v36, v29, v4
    v_and_b32 v37, v29, v5
    v_and_b32 v38, v29, v6
    v_and_b32 v39, v29, v7
    s_nop 1
    v_mfma_f32_16x16x32_bf16 v[48:51], v[76:79], v[36:39], v[48:51]
    v_and_b32 v40, v30, v4
    v_and_b32 v41, v30, v5
    v_and_b32 v42, v30, v6
    v_and_b32 v43, v30, v7
    s_nop 1
    v_mfma_f32_16x16x32_bf16 v[48:51], v[80:83], v[40:43], v[48:51]
    v_and_b32 v44, v31, v4
    v_and_b32 v45, v31, v5
    v_and_b32 v46, v31, v6
    v_and_b32 v47, v31, v7
    s_nop 1
    v_mfma_f32_16x16x32_bf16 v[48:51], v[84:87], v[44:47], v[48:51]
    s_mov_b64 exec, s[26:27]
    s_nop 6
    v_cvt_f64_f32 v[32:33], v48
    ds_add_f64 v15, v[32:33] offset:2048
    v_cvt_f64_f32 v[34:35], v49
    ds_add_f64 v15, v[34:35] offset:2112
    v_cvt_f64_f32 v[36:37], v50
    ds_add_f64 v15, v[36:37] offset:2176
    v_cvt_f64_f32 v[38:39], v51
    ds_add_f64 v15, v[38:39] offset:2240
    s_mov_b64 exec, 1
    ds_add_rtn_u32 v13, v3, v8 offset:28
    s_mov_b64 exec, -1
L_nohop9:
    s_nop 0
    ds_read_b128 v[152:155], v21 offset:2048
    ds_read_b128 v[156:159], v21 offset:2064
    s_waitcnt lgkmcnt(0)
    v_readfirstlane_b32 s3, v13
    s_cmp_lg_u32 s3, 4
    s_cbranch_scc1 NP_18
    v_cvt_f32_f64 v152, v[152:153]
    v_cvt_f32_f64 v153, v[154:155]
    v_cvt_f32_f64 v154, v[156:157]
    v_cvt_f32_f64 v155, v[158:159]
    v_perm_b32 v152, v152, v155, s59
    v_perm_b32 v153, v153, v155, s60
    v_perm_b32 v154, v154, v155, s61
    v_mov_b32 v155, s36
    s_mov_b32 exec_lo, s58
    s_mov_b32 exec_hi, 0
    global_store_dwordx4 v19, v[152:155], s[28:29] sc1
    s_mov_b64 exec, -1
NP_18:
    s_cmp_eq_u32 s43, 0
    s_cbranch_scc1 L_end
P_19:
    ds_read_b32 v10, v3 offset:28
    s_waitcnt lgkmcnt(0)
    v_readfirstlane_b32 s3, v10
    s_cmp_ge_u32 s3, 5
    s_cbranch_scc1 D_20
    s_sub_u32 s37, s37, 1
    s_cbranch_scc0 P_19
    s_mov_b32 s37, 0
D_20:
    global_load_dwordx4 v[128:131], v234, s[28:29] sc1
    global_load_dwordx4 v[132:135], v234, s[28:29] offset:256 sc1
    global_load_dwordx4 v[136:139], v235, s[28:29] sc1
L_fp:
    s_waitcnt vmcnt(3)
    v_cmp_eq_u32 vcc, s36, v91
    v_cmp_eq_u32 s[64:65], s36, v95
    s_and_b64 vcc, vcc, s[64:65]
    v_cmp_eq_u32 s[64:65], s36, v99
    s_and_b64 vcc, vcc, s[64:65]
    s_cmp_eq_u64 vcc, -1
    s_cbranch_scc1 L_fu0
    global_load_dwordx4 v[88:91], v234, s[28:29] sc1
    global_load_dwordx4 v[92:95], v234, s[28:29] offset:256 sc1
    global_load_dwordx4 v[96:99], v235, s[28:29] sc1
    s_waitcnt vmcnt(3)
    v_cmp_eq_u32 vcc, s36, v131
    v_cmp_eq_u32 s[64:65], s36, v135
    s_and_b64 vcc, vcc, s[64:65]
    v_cmp_eq_u32 s[64:65], s36, v139
    s_and_b64 vcc, vcc, s[64:65]
    s_cmp_eq_u64 vcc, -1
    s_cbranch_scc1 L_fu1
    global_load_dwordx4 v[128:131], v234, s[28:29] sc1
    global_load_dwordx4 v[132:135], v234, s[28:29] offset:256 sc1
    global_load_dwordx4 v[136:139], v235, s[28:29] sc1
    s_sub_u32 s37, s37, 1
    s_cbranch_scc0 L_fp
    s_waitcnt vmcnt(0)
L_fu0:
    v_perm_b32 v10, v89, v88, s62
    v_lshl_or_b32 v10, v90, 24, v10
    v_perm_b32 v11, v93, v92, s62
    v_lshl_or_b32 v11, v94, 24, v11
    v_perm_b32 v13, v97, v96, s62
    v_lshl_or_b32 v13, v98, 24, v13
    v_add_f32 v28, v88, v92
    v_add_f32 v29, v89, v93
    v_add_f32 v30, v90, v94
    v_add_f32 v31, v10, v11
    v_fmac_f32 v28, s15, v96
    v_fmac_f32 v29, s15, v97
    v_fmac_f32 v30, s15, v98
    v_fmac_f32 v31, s15, v13
    s_branch L_fd
L_fu1:
    v_perm_b32 v10, v129, v128, s62
    v_lshl_or_b32 v10, v130, 24, v10
    v_perm_b32 v11, v133, v132, s62
    v_lshl_or_b32 v11, v134, 24, v11
    v_perm_b32 v13, v137, v136, s62
    v_lshl_or_b32 v13, v138, 24, v13
    v_add_f32 v28, v128, v132
    v_add_f32 v29, v129, v133
    v_add_f32 v30, v130, v134
    v_add_f32 v31, v10, v11
    v_fmac_f32 v28, s15, v136
    v_fmac_f32 v29, s15, v137
    v_fmac_f32 v30, s15, v138
    v_fmac_f32 v31, s15, v13
L_fd:
    s_nop 0
    v_permlane32_swap_b32 v28, v30
    v_permlane32_swap_b32 v29, v31
    v_add_f32 v28, v28, v30
    v_add_f32 v29, v29, v31
    s_nop 1
    v_permlane16_swap_b32 v28, v29
    v_add_f32 v28, v28, v29
    s_nop 1
    v_add_f32_dpp v28, v28, v28 row_ror:8 row_mask:0xf bank_mask:0xf
    s_nop 1
    v_add_f32_dpp v28, v28, v28 row_ror:4 row_mask:0xf bank_mask:0xf
    v_add_f32 v28, v28, v226
    v_cvt_pk_bf16_f32 v28, v28, v28
    s_mov_b32 exec_lo, 0x000f000f
    s_mov_b32 exec_hi, 0x000f000f
    global_store_short v228, v28, s[24:25]
    s_cmp_lg_u32 s2, 0
    s_cbranch_scc1 L_w4z
    s_add_u32 s35, s35, 1
    s_mov_b64 exec, 1
    v_mov_b32 v10, s35
    global_store_dword v3, v10, s[28:29]
L_w4z:
L_sdone:
L_end:

s_endpgm
.section .rodata,"a"
.p2align 6
.amdhsa_kernel parallel_sum__sliding_block_cached__mixer_channel_mlp__decode_kernel
  .amdhsa_next_free_vgpr 244
  .amdhsa_next_free_sgpr 70
  .amdhsa_accum_offset 244
  .amdhsa_group_segment_fixed_size 0
  .amdhsa_kernarg_size 104
  .amdhsa_user_sgpr_count 2
  .amdhsa_user_sgpr_kernarg_segment_ptr 1
  .amdhsa_system_sgpr_workgroup_id_x 1
.end_amdhsa_kernel
```
